```python
import torch

def _softmax(x, axis=-1):
    return torch.softmax(x, dim=axis)
def _gelu(x):
    return torch.nn.functional.gelu(x, approximate="tanh")
def _silu(x):
    return torch.nn.functional.silu(x)
def _sigmoid(x):
    return torch.sigmoid(x)
def _layernorm(x, axis=-1, eps=1e-5):
    m = x.mean(dim=axis, keepdim=True)
    v = x.var(dim=axis, keepdim=True, unbiased=False)
    return (x - m) / torch.sqrt(v + eps)
def _scatter_add(tgt, idx, src, axis=0):
    return tgt.clone().index_add_(axis, idx, src)
def _segment_sum(src, seg, n):
    out = torch.zeros((n,) + src.shape[1:], dtype=src.dtype)
    return out.index_add_(0, seg, src)
def _pad(x, pw):
    flat = tuple(v for pair in reversed(pw) for v in pair)
    return torch.nn.functional.pad(x, flat)

kernel_name = 'concat_heads__gqa_block_cached__mha_block_cached__near_ridge'

def setup_inputs():

    _w = (lambda a: (lambda t: t.to(torch.bfloat16) if t.is_floating_point() else t)(torch.as_tensor(a)))
    def _A_setup():
        B, Sq, D = 16, 64, 512
        Hq, Hkv, Sk, Dh = 32, 8, 512, 128
        assert Hq % Hkv == 0, (Hq, Hkv)
        return {
            "x": _w((lambda *s: torch.randn(*s, dtype=torch.bfloat16) * 0.8)(B, Sq, D)),
            "k_cache": _w((lambda *s: torch.randn(*s, dtype=torch.bfloat16) * 0.8)(B, Hkv, Sk, Dh)),
            "v_cache": _w((lambda *s: torch.randn(*s, dtype=torch.bfloat16) * 0.05)(B, Hkv, Sk, Dh)),
            "wq": _w((lambda *s: torch.randn(*s, dtype=torch.bfloat16) * 0.8)(D, Hq * Dh) * (D ** -0.5)),
            "wo": _w((lambda *s: torch.randn(*s, dtype=torch.bfloat16) * 0.05)(Hq * Dh, D) * ((Hq * Dh) ** -0.5)),
        }
    _A_in = _A_setup()

    def _B_setup():
        B, Sq, D = 16, 64, 512
        H, Sk, Dh = 32, 512, 128
        return {
            "x": _w((lambda *s: torch.randn(*s, dtype=torch.bfloat16) * 0.8)(B, Sq, D)),
            "k_cache": _w((lambda *s: torch.randn(*s, dtype=torch.bfloat16) * 0.8)(B, H, Sk, Dh)),
            "v_cache": _w((lambda *s: torch.randn(*s, dtype=torch.bfloat16) * 0.05)(B, H, Sk, Dh)),
            "wq": _w((lambda *s: torch.randn(*s, dtype=torch.bfloat16) * 0.8)(D, H * Dh) * (D ** -0.5)),
            "wo": _w((lambda *s: torch.randn(*s, dtype=torch.bfloat16) * 0.05)(H * Dh, D) * ((H * Dh) ** -0.5)),
        }
    _B_in = _B_setup()

    return {
        "A_x": _A_in["x"],
        "A_k_cache": _A_in["k_cache"],
        "A_v_cache": _A_in["v_cache"],
        "A_wq": _A_in["wq"],
        "A_wo": _A_in["wo"],
        "B_x": _B_in["x"],
        "B_k_cache": _B_in["k_cache"],
        "B_v_cache": _B_in["v_cache"],
        "B_wq": _B_in["wq"],
        "B_wo": _B_in["wo"],
    }

def reference(A_x, A_k_cache, A_v_cache, A_wq, A_wo, B_x, B_k_cache, B_v_cache, B_wq, B_wo):
    def _A_ref(x, k_cache, v_cache, wq, wo):
        B, Sq, D = x.shape
        Hq, Dh = 32, 128
        Hkv = k_cache.shape[1]
        rep = Hq // Hkv
        q = (lambda x, *d: x.permute(*d))((x @ wq).reshape(B, Sq, Hq, Dh), 0, 2, 1, 3)
        k = (lambda x, n, axis: torch.repeat_interleave(x, n, dim=axis))(k_cache, rep, axis=1)
        v = (lambda x, n, axis: torch.repeat_interleave(x, n, dim=axis))(v_cache, rep, axis=1)
        scores = torch.einsum("bhqd,bhkd->bhqk", q, k) * (Dh ** -0.5)
        p = _softmax(scores, axis=-1)
        o = torch.einsum("bhqk,bhkd->bhqd", p, v)
        return (lambda x, *d: x.permute(*d))(o, 0, 2, 1, 3).reshape(B, Sq, Hq * Dh) @ wo

    def _B_ref(x, k_cache, v_cache, wq, wo):
        B, Sq, D = x.shape
        H, Dh = 32, 128
        q = (lambda x, *d: x.permute(*d))((x @ wq).reshape(B, Sq, H, Dh), 0, 2, 1, 3)
        scores = torch.einsum("bhqd,bhkd->bhqk", q, k_cache) * (Dh ** -0.5)
        p = _softmax(scores, axis=-1)
        o = torch.einsum("bhqk,bhkd->bhqd", p, v_cache)
        return (lambda x, *d: x.permute(*d))(o, 0, 2, 1, 3).reshape(B, Sq, H * Dh) @ wo

    a = _A_ref(A_x, A_k_cache, A_v_cache, A_wq, A_wo)
    b = _B_ref(B_x, B_k_cache, B_v_cache, B_wq, B_wo)
    return torch.concatenate([a, b], axis=-1)
```

```asm
; @launch grid=(256,1,1) block=(512,1,1) lds=163840
.amdgcn_target "amdgcn-amd-amdhsa--gfx950"
.text
.globl concat_heads__gqa_block_cached__mha_block_cached__near_ridge_kernel
.p2align 8
.type concat_heads__gqa_block_cached__mha_block_cached__near_ridge_kernel,@function
concat_heads__gqa_block_cached__mha_block_cached__near_ridge_kernel:
  s_cmp_ge_u32 s2, 256
  s_cbranch_scc1 L_end
  s_load_dwordx16 s[16:31], s[0:1], 0
  s_load_dwordx8 s[32:39], s[0:1], 64
  s_load_dwordx2 s[40:41], s[0:1], 96
  v_lshrrev_b32 v1, 6, v0
  s_nop 0
  v_readfirstlane_b32 s3, v1
  v_and_b32 v1, 63, v0
  s_and_b32 s5, s2, 7
  s_lshr_b32 s69, s2, 3
  s_and_b32 s4, s69, 15
  s_lshr_b32 s7, s69, 4
  s_lshr_b32 s8, s3, 1
  s_and_b32 s9, s3, 1
  s_lshl_b32 s6, s5, 2
  s_add_u32 s6, s6, s8
  s_lshl_b32 s75, s3, 12
  s_lshl_b32 s76, s3, 10
  s_lshl_b32 s10, s4, 1
  s_and_b32 s10, s10, 15
  v_lshlrev_b32 v2, 4, v1
  v_xor_b32 v5, 0, v2
  v_add_u32 v18, 0, v5
  v_xor_b32 v5, 64, v2
  v_add_u32 v19, 7168, v5
  v_xor_b32 v5, 128, v2
  v_add_u32 v20, 14336, v5
  v_xor_b32 v5, 192, v2
  v_add_u32 v21, 21504, v5
  s_lshl_b32 s69, s3, 2
  v_lshrrev_b32 v5, 4, v1
  v_add_u32 v5, s69, v5
  v_xor_b32 v5, v5, v1
  v_and_b32 v5, 7, v5
  v_lshlrev_b32 v5, 4, v5
  v_lshrrev_b32 v6, 3, v1
  v_lshl_add_u32 v12, v6, 10, v5
  s_waitcnt lgkmcnt(0)
  s_cmp_eq_u32 s7, 1
  s_cselect_b32 s44, s16, s26
  s_cselect_b32 s45, s17, s27
  s_cselect_b32 s48, s22, s32
  s_cselect_b32 s49, s23, s33
  s_cselect_b32 s52, s18, s28
  s_cselect_b32 s53, s19, s29
  s_cselect_b32 s56, s20, s30
  s_cselect_b32 s57, s21, s31
  s_cselect_b32 s60, s24, s34
  s_cselect_b32 s61, s25, s35
  s_lshl_b32 s69, s4, 16
  s_lshl_b32 s70, s3, 13
  s_add_u32 s69, s69, s70
  s_add_u32 s44, s44, s69
  s_addc_u32 s45, s45, 0
  s_and_b32 s45, s45, 0xffff
  s_mov_b32 s46, 8192
  s_mov_b32 s47, 0x20000
  s_and_b32 s49, s49, 0xffff
  s_mov_b32 s50, 4194304
  s_mov_b32 s51, 0x20000
  s_lshl_b32 s77, s5, 10
  s_lshl_b32 s70, s3, 15
  s_add_u32 s77, s77, s70
  s_mov_b32 s78, s10
  s_lshl_b32 s69, s78, 6
  s_add_u32 m0, s76, 131072
  s_add_u32 s78, s78, 2
  s_and_b32 s78, s78, 15
  buffer_load_dwordx4 v12, s[44:47], s69 offen lds
  s_lshl_b32 s69, s10, 18
  s_add_u32 s69, s69, s77
  s_add_u32 m0, s75, 0
  s_add_u32 s10, s10, 1
  s_and_b32 s10, s10, 15
  buffer_load_dwordx4 v18, s[48:51], s69 offen offset:0 lds
  buffer_load_dwordx4 v19, s[48:51], s69 offen offset:1024 lds
  buffer_load_dwordx4 v20, s[48:51], s69 offen offset:2048 lds
  buffer_load_dwordx4 v21, s[48:51], s69 offen offset:3072 lds
  s_lshl_b32 s69, s10, 18
  s_add_u32 s69, s69, s77
  s_add_u32 m0, s75, 32768
  s_add_u32 s10, s10, 1
  s_and_b32 s10, s10, 15
  buffer_load_dwordx4 v18, s[48:51], s69 offen offset:0 lds
  buffer_load_dwordx4 v19, s[48:51], s69 offen offset:1024 lds
  buffer_load_dwordx4 v20, s[48:51], s69 offen offset:2048 lds
  buffer_load_dwordx4 v21, s[48:51], s69 offen offset:3072 lds
  s_mov_b32 s68, 0x3e0293ee
  v_lshrrev_b32 v3, 5, v1
  v_and_b32 v4, 31, v1
  v_bfe_u32 v5, v1, 2, 2
  v_bfe_u32 v6, v1, 4, 1
  v_lshlrev_b32 v6, 5, v6
  v_and_b32 v10, 3, v1
  v_lshl_add_u32 v11, v10, 3, v6
  v_and_b32 v9, 1, v10
  v_lshlrev_b32 v9, 1, v9
  v_lshrrev_b32 v10, 1, v10
  v_or_b32 v10, v10, v9
  v_lshl_add_u32 v15, v10, 3, v6
  v_lshl_add_u32 v10, v3, 3, v5
  v_lshlrev_b32 v10, 10, v10
  v_add_u32 v10, v10, v15
  s_lshl_b32 s69, s8, 8
  v_add_u32 v10, s69, v10
  v_xor_b32 v8, 0, v5
  v_lshl_add_u32 v26, v8, 6, v10
  v_xor_b32 v8, 1, v5
  v_lshl_add_u32 v27, v8, 6, v10
  v_xor_b32 v8, 2, v5
  v_lshl_add_u32 v28, v8, 6, v10
  v_xor_b32 v8, 3, v5
  v_lshl_add_u32 v29, v8, 6, v10
  v_bfe_u32 v10, v1, 1, 3
  v_xor_b32 v10, v10, v3
  v_lshlrev_b32 v10, 4, v10
  v_lshl_add_u32 v10, v4, 7, v10
  s_lshl_b32 s69, s9, 12
  s_add_u32 s69, s69, 131072
  v_add_u32 v10, s69, v10
  v_xor_b32 v42, 0, v10
  v_xor_b32 v43, 32, v10
  v_xor_b32 v44, 64, v10
  v_xor_b32 v45, 96, v10
  s_lshl_b32 s69, s10, 18
  s_add_u32 s69, s69, s77
  s_add_u32 m0, s75, 65536
  s_add_u32 s10, s10, 1
  s_and_b32 s10, s10, 15
  buffer_load_dwordx4 v18, s[48:51], s69 offen offset:0 lds
  buffer_load_dwordx4 v19, s[48:51], s69 offen offset:1024 lds
  buffer_load_dwordx4 v20, s[48:51], s69 offen offset:2048 lds
  buffer_load_dwordx4 v21, s[48:51], s69 offen offset:3072 lds
  s_lshl_b32 s70, s8, 13
  s_cmp_eq_u32 s7, 1
  s_cselect_b32 s70, 0, s70
  v_lshl_add_u32 v10, v3, 2, v5
  v_lshlrev_b32 v10, 8, v10
  v_add_u32 v10, v10, v11
  v_add_u32 v10, s70, v10
  v_xor_b32 v8, 0, v5
  v_lshl_add_u32 v30, v8, 6, v10
  v_xor_b32 v8, 1, v5
  v_lshl_add_u32 v31, v8, 6, v10
  v_xor_b32 v8, 2, v5
  v_lshl_add_u32 v32, v8, 6, v10
  v_xor_b32 v8, 3, v5
  v_lshl_add_u32 v33, v8, 6, v10
  v_and_b32 v10, 15, v4
  v_xor_b32 v10, v10, v3
  v_lshlrev_b32 v10, 4, v10
  v_lshl_add_u32 v10, v4, 8, v10
  v_add_u32 v10, s70, v10
  v_xor_b32 v34, 0, v10
  v_xor_b32 v35, 32, v10
  v_xor_b32 v36, 64, v10
  v_xor_b32 v37, 96, v10
  v_xor_b32 v38, 128, v10
  v_xor_b32 v39, 160, v10
  v_xor_b32 v40, 192, v10
  v_xor_b32 v41, 224, v10
  v_and_b32 v9, 15, v1
  v_lshrrev_b32 v6, 4, v1
  s_lshl_b32 s69, s3, 2
  s_and_b32 s69, s69, 15
  s_cmp_eq_u32 s7, 1
  s_cselect_b32 s69, s69, 0
  s_add_u32 s71, s69, 0
  s_and_b32 s71, s71, 15
  v_or_b32 v10, s71, v6
  v_xor_b32 v10, v10, v9
  v_lshlrev_b32 v10, 4, v10
  v_lshl_add_u32 v22, v6, 8, v10
  s_add_u32 s71, s69, 4
  s_and_b32 s71, s71, 15
  v_or_b32 v10, s71, v6
  v_xor_b32 v10, v10, v9
  v_lshlrev_b32 v10, 4, v10
  v_lshl_add_u32 v23, v6, 8, v10
  s_add_u32 s71, s69, 8
  s_and_b32 s71, s71, 15
  v_or_b32 v10, s71, v6
  v_xor_b32 v10, v10, v9
  v_lshlrev_b32 v10, 4, v10
  v_lshl_add_u32 v24, v6, 8, v10
  s_add_u32 s71, s69, 12
  s_and_b32 s71, s71, 15
  v_or_b32 v10, s71, v6
  v_xor_b32 v10, v10, v9
  v_lshlrev_b32 v10, 4, v10
  v_lshl_add_u32 v25, v6, 8, v10
  v_lshlrev_b32 v10, 2, v6
  v_xor_b32 v10, v10, v9
  v_lshlrev_b32 v10, 4, v10
  v_lshl_add_u32 v14, v6, 8, v10
  s_lshl_b32 s69, s4, 3
  s_add_u32 s69, s69, s5
  s_lshl_b32 s70, s4, 5
  s_add_u32 s70, s70, s6
  s_lshl_b32 s72, s9, 12
  s_cmp_eq_u32 s7, 1
  s_cselect_b32 s69, s69, s70
  s_cselect_b32 s12, s76, s72
  s_cselect_b32 s14, s76, s75
  s_lshr_b32 s70, s69, 4
  s_add_u32 s70, s70, s69
  s_mul_i32 s70, s70, 5
  s_and_b32 s70, s70, 15
  s_lshl_b32 s70, s70, 13
  s_add_u32 s12, s12, s70
  s_mov_b32 s13, s12
  s_lshl_b32 s69, s69, 17
  s_add_u32 s52, s52, s69
  s_addc_u32 s53, s53, 0
  s_add_u32 s56, s56, s69
  s_addc_u32 s57, s57, 0
  s_and_b32 s53, s53, 0xffff
  s_mov_b32 s54, 131072
  s_mov_b32 s55, 0x20000
  s_and_b32 s57, s57, 0xffff
  s_mov_b32 s58, 131072
  s_mov_b32 s59, 0x20000
  s_and_b32 s61, s61, 0xffff
  s_mov_b32 s62, 4194304
  s_mov_b32 s63, 0x20000
  s_xor_b32 s43, s7, 1
  s_lshl_b32 s43, s43, 4
  s_add_u32 s43, s43, s4
  s_lshl_b32 s70, s43, 19
  s_add_u32 s70, s70, 1048576
  s_add_u32 s64, s40, s70
  s_addc_u32 s65, s41, 0
  s_and_b32 s65, s65, 0xffff
  s_mov_b32 s66, 524288
  s_mov_b32 s67, 0x20000
  s_lshl_b32 s70, s43, 8
  s_add_u32 s70, s70, 524288
  s_add_u32 s96, s40, s70
  s_addc_u32 s97, s41, 0
  s_and_b32 s97, s97, 0xffff
  s_mov_b32 s98, 64
  s_mov_b32 s99, 0x20000
  s_mov_b32 s84, s38
  s_mov_b32 s85, s39
  s_and_b32 s85, s85, 0xffff
  s_mov_b32 s86, 256
  s_mov_b32 s87, 0x20000
  v_xor_b32 v26, 0x10000, v26
  v_xor_b32 v27, 0x10000, v27
  v_xor_b32 v28, 0x10000, v28
  v_xor_b32 v29, 0x10000, v29
  v_mov_b32 v96, 0
  v_mov_b32 v97, 0
  v_mov_b32 v98, 0
  v_mov_b32 v99, 0
  v_mov_b32 v100, 0
  v_mov_b32 v101, 0
  v_mov_b32 v102, 0
  v_mov_b32 v103, 0
  v_mov_b32 v104, 0
  v_mov_b32 v105, 0
  v_mov_b32 v106, 0
  v_mov_b32 v107, 0
  v_mov_b32 v108, 0
  v_mov_b32 v109, 0
  v_mov_b32 v110, 0
  v_mov_b32 v111, 0
  v_mov_b32 v112, 0
  v_mov_b32 v113, 0
  v_mov_b32 v114, 0
  v_mov_b32 v115, 0
  v_mov_b32 v116, 0
  v_mov_b32 v117, 0
  v_mov_b32 v118, 0
  v_mov_b32 v119, 0
  v_mov_b32 v120, 0
  v_mov_b32 v121, 0
  v_mov_b32 v122, 0
  v_mov_b32 v123, 0
  v_mov_b32 v124, 0
  v_mov_b32 v125, 0
  v_mov_b32 v126, 0
  v_mov_b32 v127, 0
  v_mov_b32 v128, 0
  v_mov_b32 v129, 0
  v_mov_b32 v130, 0
  v_mov_b32 v131, 0
  v_mov_b32 v132, 0
  v_mov_b32 v133, 0
  v_mov_b32 v134, 0
  v_mov_b32 v135, 0
  v_mov_b32 v136, 0
  v_mov_b32 v137, 0
  v_mov_b32 v138, 0
  v_mov_b32 v139, 0
  v_mov_b32 v140, 0
  v_mov_b32 v141, 0
  v_mov_b32 v142, 0
  v_mov_b32 v143, 0
  v_mov_b32 v144, 0
  v_mov_b32 v145, 0
  v_mov_b32 v146, 0
  v_mov_b32 v147, 0
  v_mov_b32 v148, 0
  v_mov_b32 v149, 0
  v_mov_b32 v150, 0
  v_mov_b32 v151, 0
  v_mov_b32 v152, 0
  v_mov_b32 v153, 0
  v_mov_b32 v154, 0
  v_mov_b32 v155, 0
  v_mov_b32 v156, 0
  v_mov_b32 v157, 0
  v_mov_b32 v158, 0
  v_mov_b32 v159, 0
  v_mov_b32 v64, 0
  v_mov_b32 v65, 0
  v_mov_b32 v66, 0
  v_mov_b32 v67, 0
  v_mov_b32 v68, 0
  v_mov_b32 v69, 0
  v_mov_b32 v70, 0
  v_mov_b32 v71, 0
  v_mov_b32 v72, 0
  v_mov_b32 v73, 0
  v_mov_b32 v74, 0
  v_mov_b32 v75, 0
  v_mov_b32 v76, 0
  v_mov_b32 v77, 0
  v_mov_b32 v78, 0
  v_mov_b32 v79, 0
  v_mov_b32 v84, 0
  v_mov_b32 v85, 0
  v_mov_b32 v86, 0
  v_mov_b32 v87, 0
  s_mov_b32 s11, 3
  s_nop 1
L_q:
  s_waitcnt vmcnt(8)
  s_waitcnt lgkmcnt(0)
  s_barrier
  v_xor_b32 v26, 0x10000, v26
  v_xor_b32 v27, 0x10000, v27
  v_xor_b32 v28, 0x10000, v28
  v_xor_b32 v29, 0x10000, v29
  ds_read_b128 v[80:83], v42 offset:0
  ds_read_b64_tr_b16 v[48:49], v26 offset:0
  ds_read_b64_tr_b16 v[50:51], v26 offset:4096
  ds_read_b64_tr_b16 v[52:53], v27 offset:0
  ds_read_b64_tr_b16 v[54:55], v27 offset:4096
  ds_read_b64_tr_b16 v[56:57], v28 offset:0
  ds_read_b64_tr_b16 v[58:59], v28 offset:4096
  ds_read_b64_tr_b16 v[60:61], v29 offset:0
  ds_read_b64_tr_b16 v[62:63], v29 offset:4096
  v_mfma_f32_32x32x16_bf16 v[96:111], v[64:67], v[84:87], v[96:111]
  s_lshl_b32 s69, s78, 6
  s_add_u32 m0, s76, 139264
  s_add_u32 s78, s78, 2
  s_and_b32 s78, s78, 15
  buffer_load_dwordx4 v12, s[44:47], s69 offen lds
  v_mfma_f32_32x32x16_bf16 v[112:127], v[68:71], v[84:87], v[112:127]
  v_mfma_f32_32x32x16_bf16 v[128:143], v[72:75], v[84:87], v[128:143]
  s_lshl_b32 s69, s10, 18
  s_add_u32 s69, s69, s77
  s_add_u32 m0, s75, 98304
  s_add_u32 s10, s10, 1
  s_and_b32 s10, s10, 15
  buffer_load_dwordx4 v18, s[48:51], s69 offen offset:0 lds
  v_mfma_f32_32x32x16_bf16 v[144:159], v[76:79], v[84:87], v[144:159]
  ds_read_b128 v[84:87], v43 offset:0
  ds_read_b64_tr_b16 v[64:65], v26 offset:16384
  ds_read_b64_tr_b16 v[66:67], v26 offset:20480
  ds_read_b64_tr_b16 v[68:69], v27 offset:16384
  ds_read_b64_tr_b16 v[70:71], v27 offset:20480
  ds_read_b64_tr_b16 v[72:73], v28 offset:16384
  ds_read_b64_tr_b16 v[74:75], v28 offset:20480
  ds_read_b64_tr_b16 v[76:77], v29 offset:16384
  ds_read_b64_tr_b16 v[78:79], v29 offset:20480
  s_waitcnt lgkmcnt(15)
  v_mfma_f32_32x32x16_bf16 v[96:111], v[48:51], v[80:83], v[96:111]
  buffer_load_dwordx4 v19, s[48:51], s69 offen offset:1024 lds
  s_waitcnt lgkmcnt(13)
  v_mfma_f32_32x32x16_bf16 v[112:127], v[52:55], v[80:83], v[112:127]
  buffer_load_dwordx4 v20, s[48:51], s69 offen offset:2048 lds
  s_waitcnt lgkmcnt(11)
  v_mfma_f32_32x32x16_bf16 v[128:143], v[56:59], v[80:83], v[128:143]
  s_waitcnt lgkmcnt(9)
  v_mfma_f32_32x32x16_bf16 v[144:159], v[60:63], v[80:83], v[144:159]
  buffer_load_dwordx4 v21, s[48:51], s69 offen offset:3072 lds
  s_waitcnt vmcnt(9)
  s_waitcnt lgkmcnt(0)
  s_barrier
  ds_read_b128 v[80:83], v44 offset:0
  ds_read_b64_tr_b16 v[48:49], v26 offset:32768
  ds_read_b64_tr_b16 v[50:51], v26 offset:36864
  ds_read_b64_tr_b16 v[52:53], v27 offset:32768
  ds_read_b64_tr_b16 v[54:55], v27 offset:36864
  ds_read_b64_tr_b16 v[56:57], v28 offset:32768
  ds_read_b64_tr_b16 v[58:59], v28 offset:36864
  ds_read_b64_tr_b16 v[60:61], v29 offset:32768
  ds_read_b64_tr_b16 v[62:63], v29 offset:36864
  v_mfma_f32_32x32x16_bf16 v[96:111], v[64:67], v[84:87], v[96:111]
  s_lshl_b32 s69, s10, 18
  s_add_u32 s69, s69, s77
  s_add_u32 m0, s75, 0
  s_add_u32 s10, s10, 1
  s_and_b32 s10, s10, 15
  buffer_load_dwordx4 v18, s[48:51], s69 offen offset:0 lds
  v_mfma_f32_32x32x16_bf16 v[112:127], v[68:71], v[84:87], v[112:127]
  v_mfma_f32_32x32x16_bf16 v[128:143], v[72:75], v[84:87], v[128:143]
  buffer_load_dwordx4 v19, s[48:51], s69 offen offset:1024 lds
  v_mfma_f32_32x32x16_bf16 v[144:159], v[76:79], v[84:87], v[144:159]
  ds_read_b128 v[84:87], v45 offset:0
  ds_read_b64_tr_b16 v[64:65], v26 offset:49152
  ds_read_b64_tr_b16 v[66:67], v26 offset:53248
  ds_read_b64_tr_b16 v[68:69], v27 offset:49152
  ds_read_b64_tr_b16 v[70:71], v27 offset:53248
  ds_read_b64_tr_b16 v[72:73], v28 offset:49152
  ds_read_b64_tr_b16 v[74:75], v28 offset:53248
  ds_read_b64_tr_b16 v[76:77], v29 offset:49152
  ds_read_b64_tr_b16 v[78:79], v29 offset:53248
  s_waitcnt lgkmcnt(15)
  v_mfma_f32_32x32x16_bf16 v[96:111], v[48:51], v[80:83], v[96:111]
  buffer_load_dwordx4 v20, s[48:51], s69 offen offset:2048 lds
  s_waitcnt lgkmcnt(13)
  v_mfma_f32_32x32x16_bf16 v[112:127], v[52:55], v[80:83], v[112:127]
  s_waitcnt lgkmcnt(11)
  v_mfma_f32_32x32x16_bf16 v[128:143], v[56:59], v[80:83], v[128:143]
  buffer_load_dwordx4 v21, s[48:51], s69 offen offset:3072 lds
  s_waitcnt lgkmcnt(9)
  v_mfma_f32_32x32x16_bf16 v[144:159], v[60:63], v[80:83], v[144:159]
  s_waitcnt vmcnt(8)
  s_waitcnt lgkmcnt(0)
  s_barrier
  v_xor_b32 v26, 0x10000, v26
  v_xor_b32 v27, 0x10000, v27
  v_xor_b32 v28, 0x10000, v28
  v_xor_b32 v29, 0x10000, v29
  ds_read_b128 v[80:83], v42 offset:8192
  ds_read_b64_tr_b16 v[48:49], v26 offset:0
  ds_read_b64_tr_b16 v[50:51], v26 offset:4096
  ds_read_b64_tr_b16 v[52:53], v27 offset:0
  ds_read_b64_tr_b16 v[54:55], v27 offset:4096
  ds_read_b64_tr_b16 v[56:57], v28 offset:0
  ds_read_b64_tr_b16 v[58:59], v28 offset:4096
  ds_read_b64_tr_b16 v[60:61], v29 offset:0
  ds_read_b64_tr_b16 v[62:63], v29 offset:4096
  v_mfma_f32_32x32x16_bf16 v[96:111], v[64:67], v[84:87], v[96:111]
  s_lshl_b32 s69, s78, 6
  s_add_u32 m0, s76, 131072
  s_add_u32 s78, s78, 2
  s_and_b32 s78, s78, 15
  buffer_load_dwordx4 v12, s[44:47], s69 offen lds
  v_mfma_f32_32x32x16_bf16 v[112:127], v[68:71], v[84:87], v[112:127]
  v_mfma_f32_32x32x16_bf16 v[128:143], v[72:75], v[84:87], v[128:143]
  s_lshl_b32 s69, s10, 18
  s_add_u32 s69, s69, s77
  s_add_u32 m0, s75, 32768
  s_add_u32 s10, s10, 1
  s_and_b32 s10, s10, 15
  buffer_load_dwordx4 v18, s[48:51], s69 offen offset:0 lds
  v_mfma_f32_32x32x16_bf16 v[144:159], v[76:79], v[84:87], v[144:159]
  ds_read_b128 v[84:87], v43 offset:8192
  ds_read_b64_tr_b16 v[64:65], v26 offset:16384
  ds_read_b64_tr_b16 v[66:67], v26 offset:20480
  ds_read_b64_tr_b16 v[68:69], v27 offset:16384
  ds_read_b64_tr_b16 v[70:71], v27 offset:20480
  ds_read_b64_tr_b16 v[72:73], v28 offset:16384
  ds_read_b64_tr_b16 v[74:75], v28 offset:20480
  ds_read_b64_tr_b16 v[76:77], v29 offset:16384
  ds_read_b64_tr_b16 v[78:79], v29 offset:20480
  s_waitcnt lgkmcnt(15)
  v_mfma_f32_32x32x16_bf16 v[96:111], v[48:51], v[80:83], v[96:111]
  buffer_load_dwordx4 v19, s[48:51], s69 offen offset:1024 lds
  s_waitcnt lgkmcnt(13)
  v_mfma_f32_32x32x16_bf16 v[112:127], v[52:55], v[80:83], v[112:127]
  buffer_load_dwordx4 v20, s[48:51], s69 offen offset:2048 lds
  s_waitcnt lgkmcnt(11)
  v_mfma_f32_32x32x16_bf16 v[128:143], v[56:59], v[80:83], v[128:143]
  s_waitcnt lgkmcnt(9)
  v_mfma_f32_32x32x16_bf16 v[144:159], v[60:63], v[80:83], v[144:159]
  buffer_load_dwordx4 v21, s[48:51], s69 offen offset:3072 lds
  s_waitcnt vmcnt(9)
  s_waitcnt lgkmcnt(0)
  s_barrier
  ds_read_b128 v[80:83], v44 offset:8192
  ds_read_b64_tr_b16 v[48:49], v26 offset:32768
  ds_read_b64_tr_b16 v[50:51], v26 offset:36864
  ds_read_b64_tr_b16 v[52:53], v27 offset:32768
  ds_read_b64_tr_b16 v[54:55], v27 offset:36864
  ds_read_b64_tr_b16 v[56:57], v28 offset:32768
  ds_read_b64_tr_b16 v[58:59], v28 offset:36864
  ds_read_b64_tr_b16 v[60:61], v29 offset:32768
  ds_read_b64_tr_b16 v[62:63], v29 offset:36864
  v_mfma_f32_32x32x16_bf16 v[96:111], v[64:67], v[84:87], v[96:111]
  s_lshl_b32 s69, s10, 18
  s_add_u32 s69, s69, s77
  s_add_u32 m0, s75, 65536
  s_add_u32 s10, s10, 1
  s_and_b32 s10, s10, 15
  buffer_load_dwordx4 v18, s[48:51], s69 offen offset:0 lds
  v_mfma_f32_32x32x16_bf16 v[112:127], v[68:71], v[84:87], v[112:127]
  v_mfma_f32_32x32x16_bf16 v[128:143], v[72:75], v[84:87], v[128:143]
  buffer_load_dwordx4 v19, s[48:51], s69 offen offset:1024 lds
  v_mfma_f32_32x32x16_bf16 v[144:159], v[76:79], v[84:87], v[144:159]
  ds_read_b128 v[84:87], v45 offset:8192
  ds_read_b64_tr_b16 v[64:65], v26 offset:49152
  ds_read_b64_tr_b16 v[66:67], v26 offset:53248
  ds_read_b64_tr_b16 v[68:69], v27 offset:49152
  ds_read_b64_tr_b16 v[70:71], v27 offset:53248
  ds_read_b64_tr_b16 v[72:73], v28 offset:49152
  ds_read_b64_tr_b16 v[74:75], v28 offset:53248
  ds_read_b64_tr_b16 v[76:77], v29 offset:49152
  ds_read_b64_tr_b16 v[78:79], v29 offset:53248
  s_waitcnt lgkmcnt(15)
  v_mfma_f32_32x32x16_bf16 v[96:111], v[48:51], v[80:83], v[96:111]
  buffer_load_dwordx4 v20, s[48:51], s69 offen offset:2048 lds
  s_waitcnt lgkmcnt(13)
  v_mfma_f32_32x32x16_bf16 v[112:127], v[52:55], v[80:83], v[112:127]
  s_waitcnt lgkmcnt(11)
  v_mfma_f32_32x32x16_bf16 v[128:143], v[56:59], v[80:83], v[128:143]
  buffer_load_dwordx4 v21, s[48:51], s69 offen offset:3072 lds
  s_waitcnt lgkmcnt(9)
  v_mfma_f32_32x32x16_bf16 v[144:159], v[60:63], v[80:83], v[144:159]
  s_sub_u32 s11, s11, 1
  s_cmp_lg_u32 s11, 0
  s_nop 9
  s_cbranch_scc1 L_q
  s_waitcnt vmcnt(8)
  s_waitcnt lgkmcnt(0)
  s_barrier
  v_xor_b32 v26, 0x10000, v26
  v_xor_b32 v27, 0x10000, v27
  v_xor_b32 v28, 0x10000, v28
  v_xor_b32 v29, 0x10000, v29
  ds_read_b128 v[80:83], v42 offset:0
  ds_read_b64_tr_b16 v[48:49], v26 offset:0
  ds_read_b64_tr_b16 v[50:51], v26 offset:4096
  ds_read_b64_tr_b16 v[52:53], v27 offset:0
  ds_read_b64_tr_b16 v[54:55], v27 offset:4096
  ds_read_b64_tr_b16 v[56:57], v28 offset:0
  ds_read_b64_tr_b16 v[58:59], v28 offset:4096
  ds_read_b64_tr_b16 v[60:61], v29 offset:0
  ds_read_b64_tr_b16 v[62:63], v29 offset:4096
  v_mfma_f32_32x32x16_bf16 v[96:111], v[64:67], v[84:87], v[96:111]
  s_lshl_b32 s69, s78, 6
  s_add_u32 m0, s76, 139264
  s_add_u32 s78, s78, 2
  s_and_b32 s78, s78, 15
  buffer_load_dwordx4 v12, s[44:47], s69 offen lds
  v_mfma_f32_32x32x16_bf16 v[112:127], v[68:71], v[84:87], v[112:127]
  v_mfma_f32_32x32x16_bf16 v[128:143], v[72:75], v[84:87], v[128:143]
  s_lshl_b32 s69, s10, 18
  s_add_u32 s69, s69, s77
  s_add_u32 m0, s75, 98304
  s_add_u32 s10, s10, 1
  s_and_b32 s10, s10, 15
  buffer_load_dwordx4 v18, s[48:51], s69 offen offset:0 lds
  v_mfma_f32_32x32x16_bf16 v[144:159], v[76:79], v[84:87], v[144:159]
  ds_read_b128 v[84:87], v43 offset:0
  ds_read_b64_tr_b16 v[64:65], v26 offset:16384
  ds_read_b64_tr_b16 v[66:67], v26 offset:20480
  ds_read_b64_tr_b16 v[68:69], v27 offset:16384
  ds_read_b64_tr_b16 v[70:71], v27 offset:20480
  ds_read_b64_tr_b16 v[72:73], v28 offset:16384
  ds_read_b64_tr_b16 v[74:75], v28 offset:20480
  ds_read_b64_tr_b16 v[76:77], v29 offset:16384
  ds_read_b64_tr_b16 v[78:79], v29 offset:20480
  s_waitcnt lgkmcnt(15)
  v_mfma_f32_32x32x16_bf16 v[96:111], v[48:51], v[80:83], v[96:111]
  buffer_load_dwordx4 v19, s[48:51], s69 offen offset:1024 lds
  s_waitcnt lgkmcnt(13)
  v_mfma_f32_32x32x16_bf16 v[112:127], v[52:55], v[80:83], v[112:127]
  buffer_load_dwordx4 v20, s[48:51], s69 offen offset:2048 lds
  s_waitcnt lgkmcnt(11)
  v_mfma_f32_32x32x16_bf16 v[128:143], v[56:59], v[80:83], v[128:143]
  s_waitcnt lgkmcnt(9)
  v_mfma_f32_32x32x16_bf16 v[144:159], v[60:63], v[80:83], v[144:159]
  buffer_load_dwordx4 v21, s[48:51], s69 offen offset:3072 lds
  s_cmp_eq_u32 s7, 1
  s_nop 9
  s_cbranch_scc1 L_A
  s_waitcnt vmcnt(9)
  s_waitcnt lgkmcnt(0)
  s_barrier
  ds_read_b128 v[80:83], v44 offset:0
  ds_read_b64_tr_b16 v[48:49], v26 offset:32768
  ds_read_b64_tr_b16 v[50:51], v26 offset:36864
  ds_read_b64_tr_b16 v[52:53], v27 offset:32768
  ds_read_b64_tr_b16 v[54:55], v27 offset:36864
  ds_read_b64_tr_b16 v[56:57], v28 offset:32768
  ds_read_b64_tr_b16 v[58:59], v28 offset:36864
  ds_read_b64_tr_b16 v[60:61], v29 offset:32768
  ds_read_b64_tr_b16 v[62:63], v29 offset:36864
  v_mfma_f32_32x32x16_bf16 v[96:111], v[64:67], v[84:87], v[96:111]
  s_add_u32 m0, s14, 0
  s_nop 0
  buffer_load_dwordx4 v22, s[52:55], s12 offen offset:0 nt lds
  v_mfma_f32_32x32x16_bf16 v[112:127], v[68:71], v[84:87], v[112:127]
  v_mfma_f32_32x32x16_bf16 v[128:143], v[72:75], v[84:87], v[128:143]
  buffer_load_dwordx4 v23, s[52:55], s12 offen offset:1024 nt lds
  v_mfma_f32_32x32x16_bf16 v[144:159], v[76:79], v[84:87], v[144:159]
  ds_read_b128 v[84:87], v45 offset:0
  ds_read_b64_tr_b16 v[64:65], v26 offset:49152
  ds_read_b64_tr_b16 v[66:67], v26 offset:53248
  ds_read_b64_tr_b16 v[68:69], v27 offset:49152
  ds_read_b64_tr_b16 v[70:71], v27 offset:53248
  ds_read_b64_tr_b16 v[72:73], v28 offset:49152
  ds_read_b64_tr_b16 v[74:75], v28 offset:53248
  ds_read_b64_tr_b16 v[76:77], v29 offset:49152
  ds_read_b64_tr_b16 v[78:79], v29 offset:53248
  s_waitcnt lgkmcnt(15)
  v_mfma_f32_32x32x16_bf16 v[96:111], v[48:51], v[80:83], v[96:111]
  buffer_load_dwordx4 v24, s[52:55], s12 offen offset:2048 nt lds
  s_waitcnt lgkmcnt(13)
  v_mfma_f32_32x32x16_bf16 v[112:127], v[52:55], v[80:83], v[112:127]
  s_waitcnt lgkmcnt(11)
  v_mfma_f32_32x32x16_bf16 v[128:143], v[56:59], v[80:83], v[128:143]
  buffer_load_dwordx4 v25, s[52:55], s12 offen offset:3072 nt lds
  s_add_u32 s12, s12, 8192
  s_and_b32 s12, s12, 0x1ffff
  s_waitcnt lgkmcnt(9)
  v_mfma_f32_32x32x16_bf16 v[144:159], v[60:63], v[80:83], v[144:159]
  s_waitcnt vmcnt(8)
  s_waitcnt lgkmcnt(0)
  s_barrier
  v_xor_b32 v26, 0x10000, v26
  v_xor_b32 v27, 0x10000, v27
  v_xor_b32 v28, 0x10000, v28
  v_xor_b32 v29, 0x10000, v29
  ds_read_b128 v[80:83], v42 offset:8192
  ds_read_b64_tr_b16 v[48:49], v26 offset:0
  ds_read_b64_tr_b16 v[50:51], v26 offset:4096
  ds_read_b64_tr_b16 v[52:53], v27 offset:0
  ds_read_b64_tr_b16 v[54:55], v27 offset:4096
  ds_read_b64_tr_b16 v[56:57], v28 offset:0
  ds_read_b64_tr_b16 v[58:59], v28 offset:4096
  ds_read_b64_tr_b16 v[60:61], v29 offset:0
  ds_read_b64_tr_b16 v[62:63], v29 offset:4096
  v_mfma_f32_32x32x16_bf16 v[96:111], v[64:67], v[84:87], v[96:111]
  s_add_u32 m0, s14, 32768
  s_nop 0
  buffer_load_dwordx4 v22, s[52:55], s12 offen offset:0 nt lds
  v_mfma_f32_32x32x16_bf16 v[112:127], v[68:71], v[84:87], v[112:127]
  v_mfma_f32_32x32x16_bf16 v[128:143], v[72:75], v[84:87], v[128:143]
  buffer_load_dwordx4 v23, s[52:55], s12 offen offset:1024 nt lds
  v_mfma_f32_32x32x16_bf16 v[144:159], v[76:79], v[84:87], v[144:159]
  ds_read_b128 v[84:87], v43 offset:8192
  ds_read_b64_tr_b16 v[64:65], v26 offset:16384
  ds_read_b64_tr_b16 v[66:67], v26 offset:20480
  ds_read_b64_tr_b16 v[68:69], v27 offset:16384
  ds_read_b64_tr_b16 v[70:71], v27 offset:20480
  ds_read_b64_tr_b16 v[72:73], v28 offset:16384
  ds_read_b64_tr_b16 v[74:75], v28 offset:20480
  ds_read_b64_tr_b16 v[76:77], v29 offset:16384
  ds_read_b64_tr_b16 v[78:79], v29 offset:20480
  s_waitcnt lgkmcnt(15)
  v_mfma_f32_32x32x16_bf16 v[96:111], v[48:51], v[80:83], v[96:111]
  buffer_load_dwordx4 v24, s[52:55], s12 offen offset:2048 nt lds
  s_waitcnt lgkmcnt(13)
  v_mfma_f32_32x32x16_bf16 v[112:127], v[52:55], v[80:83], v[112:127]
  s_waitcnt lgkmcnt(11)
  v_mfma_f32_32x32x16_bf16 v[128:143], v[56:59], v[80:83], v[128:143]
  buffer_load_dwordx4 v25, s[52:55], s12 offen offset:3072 nt lds
  s_add_u32 s12, s12, 8192
  s_and_b32 s12, s12, 0x1ffff
  s_waitcnt lgkmcnt(9)
  v_mfma_f32_32x32x16_bf16 v[144:159], v[60:63], v[80:83], v[144:159]
  s_waitcnt vmcnt(8)
  s_waitcnt lgkmcnt(0)
  s_barrier
  ds_read_b128 v[80:83], v44 offset:8192
  ds_read_b64_tr_b16 v[48:49], v26 offset:32768
  ds_read_b64_tr_b16 v[50:51], v26 offset:36864
  ds_read_b64_tr_b16 v[52:53], v27 offset:32768
  ds_read_b64_tr_b16 v[54:55], v27 offset:36864
  ds_read_b64_tr_b16 v[56:57], v28 offset:32768
  ds_read_b64_tr_b16 v[58:59], v28 offset:36864
  ds_read_b64_tr_b16 v[60:61], v29 offset:32768
  ds_read_b64_tr_b16 v[62:63], v29 offset:36864
  v_mfma_f32_32x32x16_bf16 v[96:111], v[64:67], v[84:87], v[96:111]
  s_add_u32 m0, s14, 65536
  s_nop 0
  buffer_load_dwordx4 v14, s[56:59], s13 offen offset:0 nt lds
  v_mfma_f32_32x32x16_bf16 v[112:127], v[68:71], v[84:87], v[112:127]
  v_mfma_f32_32x32x16_bf16 v[128:143], v[72:75], v[84:87], v[128:143]
  buffer_load_dwordx4 v14, s[56:59], s13 offen offset:1024 nt lds
  v_mfma_f32_32x32x16_bf16 v[144:159], v[76:79], v[84:87], v[144:159]
  ds_read_b128 v[84:87], v45 offset:8192
  ds_read_b64_tr_b16 v[64:65], v26 offset:49152
  ds_read_b64_tr_b16 v[66:67], v26 offset:53248
  ds_read_b64_tr_b16 v[68:69], v27 offset:49152
  ds_read_b64_tr_b16 v[70:71], v27 offset:53248
  ds_read_b64_tr_b16 v[72:73], v28 offset:49152
  ds_read_b64_tr_b16 v[74:75], v28 offset:53248
  ds_read_b64_tr_b16 v[76:77], v29 offset:49152
  ds_read_b64_tr_b16 v[78:79], v29 offset:53248
  s_waitcnt lgkmcnt(15)
  v_mfma_f32_32x32x16_bf16 v[96:111], v[48:51], v[80:83], v[96:111]
  buffer_load_dwordx4 v14, s[56:59], s13 offen offset:2048 nt lds
  s_waitcnt lgkmcnt(13)
  v_mfma_f32_32x32x16_bf16 v[112:127], v[52:55], v[80:83], v[112:127]
  s_waitcnt lgkmcnt(11)
  v_mfma_f32_32x32x16_bf16 v[128:143], v[56:59], v[80:83], v[128:143]
  buffer_load_dwordx4 v14, s[56:59], s13 offen offset:3072 nt lds
  s_add_u32 s13, s13, 8192
  s_and_b32 s13, s13, 0x1ffff
  s_waitcnt lgkmcnt(9)
  v_mfma_f32_32x32x16_bf16 v[144:159], v[60:63], v[80:83], v[144:159]
  s_waitcnt lgkmcnt(6)
  v_mfma_f32_32x32x16_bf16 v[96:111], v[64:67], v[84:87], v[96:111]
  s_waitcnt lgkmcnt(4)
  v_mfma_f32_32x32x16_bf16 v[112:127], v[68:71], v[84:87], v[112:127]
  s_waitcnt lgkmcnt(2)
  v_mfma_f32_32x32x16_bf16 v[128:143], v[72:75], v[84:87], v[128:143]
  s_waitcnt lgkmcnt(0)
  v_mfma_f32_32x32x16_bf16 v[144:159], v[76:79], v[84:87], v[144:159]
  s_nop 5
  v_cvt_pk_bf16_f32 v192, v96, v97
  v_cvt_pk_bf16_f32 v193, v98, v99
  v_cvt_pk_bf16_f32 v194, v100, v101
  v_cvt_pk_bf16_f32 v195, v102, v103
  v_cvt_pk_bf16_f32 v196, v104, v105
  v_cvt_pk_bf16_f32 v197, v106, v107
  v_cvt_pk_bf16_f32 v198, v108, v109
  v_cvt_pk_bf16_f32 v199, v110, v111
  v_cvt_pk_bf16_f32 v200, v112, v113
  v_cvt_pk_bf16_f32 v201, v114, v115
  v_cvt_pk_bf16_f32 v202, v116, v117
  v_cvt_pk_bf16_f32 v203, v118, v119
  v_cvt_pk_bf16_f32 v204, v120, v121
  v_cvt_pk_bf16_f32 v205, v122, v123
  v_cvt_pk_bf16_f32 v206, v124, v125
  v_cvt_pk_bf16_f32 v207, v126, v127
  v_cvt_pk_bf16_f32 v208, v128, v129
  v_cvt_pk_bf16_f32 v209, v130, v131
  v_cvt_pk_bf16_f32 v210, v132, v133
  v_cvt_pk_bf16_f32 v211, v134, v135
  v_cvt_pk_bf16_f32 v212, v136, v137
  v_cvt_pk_bf16_f32 v213, v138, v139
  v_cvt_pk_bf16_f32 v214, v140, v141
  v_cvt_pk_bf16_f32 v215, v142, v143
  v_cvt_pk_bf16_f32 v216, v144, v145
  v_cvt_pk_bf16_f32 v217, v146, v147
  v_cvt_pk_bf16_f32 v218, v148, v149
  v_cvt_pk_bf16_f32 v219, v150, v151
  v_cvt_pk_bf16_f32 v220, v152, v153
  v_cvt_pk_bf16_f32 v221, v154, v155
  v_cvt_pk_bf16_f32 v222, v156, v157
  v_cvt_pk_bf16_f32 v223, v158, v159
  v_mov_b32 v8, 0
  s_waitcnt vmcnt(8)
  s_barrier
  s_cmp_lt_u32 s3, 4
  s_cbranch_scc0 L_g753
  s_add_u32 m0, s14, 98304
  s_nop 0
  buffer_load_dwordx4 v22, s[52:55], s12 offen offset:0 nt lds
  buffer_load_dwordx4 v23, s[52:55], s12 offen offset:1024 nt lds
  buffer_load_dwordx4 v24, s[52:55], s12 offen offset:2048 nt lds
  buffer_load_dwordx4 v25, s[52:55], s12 offen offset:3072 nt lds
  s_add_u32 s12, s12, 8192
  s_and_b32 s12, s12, 0x1ffff
L_g753:
  ds_read_b128 v[48:51], v34 offset:0
  ds_read_b128 v[52:55], v35 offset:0
  ds_read_b128 v[56:59], v36 offset:0
  ds_read_b128 v[60:63], v37 offset:0
  ds_read_b128 v[64:67], v38 offset:0
  ds_read_b128 v[68:71], v39 offset:0
  ds_read_b128 v[72:75], v40 offset:0
  ds_read_b128 v[76:79], v41 offset:0
  s_waitcnt lgkmcnt(7)
  v_mfma_f32_32x32x16_bf16 v[160:175], v[48:51], v[192:195], 0
  s_waitcnt lgkmcnt(6)
  v_mfma_f32_32x32x16_bf16 v[160:175], v[52:55], v[196:199], v[160:175]
  s_waitcnt lgkmcnt(5)
  v_mfma_f32_32x32x16_bf16 v[160:175], v[56:59], v[200:203], v[160:175]
  s_waitcnt lgkmcnt(4)
  v_mfma_f32_32x32x16_bf16 v[160:175], v[60:63], v[204:207], v[160:175]
  s_waitcnt lgkmcnt(3)
  v_mfma_f32_32x32x16_bf16 v[160:175], v[64:67], v[208:211], v[160:175]
  s_waitcnt lgkmcnt(2)
  v_mfma_f32_32x32x16_bf16 v[160:175], v[68:71], v[212:215], v[160:175]
  s_waitcnt lgkmcnt(1)
  v_mfma_f32_32x32x16_bf16 v[160:175], v[72:75], v[216:219], v[160:175]
  s_waitcnt lgkmcnt(0)
  v_mfma_f32_32x32x16_bf16 v[160:175], v[76:79], v[220:223], v[160:175]
  s_cmp_lt_u32 s3, 4
  s_cbranch_scc1 L_g787
  s_add_u32 m0, s14, 98304
  s_nop 0
  buffer_load_dwordx4 v22, s[52:55], s12 offen offset:0 nt lds
  buffer_load_dwordx4 v23, s[52:55], s12 offen offset:1024 nt lds
  buffer_load_dwordx4 v24, s[52:55], s12 offen offset:2048 nt lds
  buffer_load_dwordx4 v25, s[52:55], s12 offen offset:3072 nt lds
  s_add_u32 s12, s12, 8192
  s_and_b32 s12, s12, 0x1ffff
L_g787:
  s_nop 9
  v_max3_f32 v9, v160, v161, v162
  v_max3_f32 v9, v9, v163, v164
  v_max3_f32 v9, v9, v165, v166
  v_max3_f32 v9, v9, v167, v168
  v_max3_f32 v9, v9, v169, v170
  v_max3_f32 v9, v9, v171, v172
  v_max3_f32 v9, v9, v173, v174
  v_max_f32 v9, v9, v175
  v_mov_b32 v10, v9
  s_nop 1
  v_permlane32_swap_b32 v9, v10
  v_max_f32 v9, v9, v10
  v_mul_f32 v9, s68, v9
  v_sub_f32 v7, 0, v9
  s_waitcnt vmcnt(8)
  s_barrier
  s_cmp_lt_u32 s3, 4
  s_cbranch_scc0 L_g814
  s_add_u32 m0, s14, 0
  s_nop 0
  buffer_load_dwordx4 v14, s[56:59], s13 offen offset:0 nt lds
  buffer_load_dwordx4 v14, s[56:59], s13 offen offset:1024 nt lds
  buffer_load_dwordx4 v14, s[56:59], s13 offen offset:2048 nt lds
  buffer_load_dwordx4 v14, s[56:59], s13 offen offset:3072 nt lds
  s_add_u32 s13, s13, 8192
  s_and_b32 s13, s13, 0x1ffff
L_g814:
  ds_read_b128 v[48:51], v34 offset:32768
  ds_read_b128 v[52:55], v35 offset:32768
  ds_read_b128 v[56:59], v36 offset:32768
  ds_read_b128 v[60:63], v37 offset:32768
  ds_read_b128 v[64:67], v38 offset:32768
  ds_read_b128 v[68:71], v39 offset:32768
  ds_read_b128 v[72:75], v40 offset:32768
  ds_read_b128 v[76:79], v41 offset:32768
  v_fma_f32 v160, v160, s68, v7
  v_fma_f32 v161, v161, s68, v7
  v_fma_f32 v162, v162, s68, v7
  v_fma_f32 v163, v163, s68, v7
  v_exp_f32 v160, v160
  v_exp_f32 v161, v161
  v_exp_f32 v162, v162
  v_exp_f32 v163, v163
  v_add_f32 v8, v8, v160
  v_add_f32 v8, v8, v161
  v_add_f32 v8, v8, v162
  v_add_f32 v8, v8, v163
  v_cvt_pk_bf16_f32 v160, v160, v161
  v_cvt_pk_bf16_f32 v161, v162, v163
  s_waitcnt lgkmcnt(7)
  v_mfma_f32_32x32x16_bf16 v[176:191], v[48:51], v[192:195], 0
  v_fma_f32 v164, v164, s68, v7
  v_fma_f32 v165, v165, s68, v7
  v_fma_f32 v166, v166, s68, v7
  v_fma_f32 v167, v167, s68, v7
  v_exp_f32 v164, v164
  s_waitcnt lgkmcnt(6)
  v_mfma_f32_32x32x16_bf16 v[176:191], v[52:55], v[196:199], v[176:191]
  v_exp_f32 v165, v165
  v_exp_f32 v166, v166
  v_exp_f32 v167, v167
  v_add_f32 v8, v8, v164
  v_add_f32 v8, v8, v165
  s_waitcnt lgkmcnt(5)
  v_mfma_f32_32x32x16_bf16 v[176:191], v[56:59], v[200:203], v[176:191]
  v_add_f32 v8, v8, v166
  v_add_f32 v8, v8, v167
  v_cvt_pk_bf16_f32 v162, v164, v165
  v_cvt_pk_bf16_f32 v163, v166, v167
  v_fma_f32 v168, v168, s68, v7
  v_fma_f32 v169, v169, s68, v7
  s_waitcnt lgkmcnt(4)
  v_mfma_f32_32x32x16_bf16 v[176:191], v[60:63], v[204:207], v[176:191]
  v_fma_f32 v170, v170, s68, v7
  v_fma_f32 v171, v171, s68, v7
  v_exp_f32 v168, v168
  v_exp_f32 v169, v169
  v_exp_f32 v170, v170
  s_waitcnt lgkmcnt(3)
  v_mfma_f32_32x32x16_bf16 v[176:191], v[64:67], v[208:211], v[176:191]
  v_exp_f32 v171, v171
  v_add_f32 v8, v8, v168
  v_add_f32 v8, v8, v169
  v_add_f32 v8, v8, v170
  v_add_f32 v8, v8, v171
  s_waitcnt lgkmcnt(2)
  v_mfma_f32_32x32x16_bf16 v[176:191], v[68:71], v[212:215], v[176:191]
  v_cvt_pk_bf16_f32 v164, v168, v169
  v_cvt_pk_bf16_f32 v165, v170, v171
  v_fma_f32 v172, v172, s68, v7
  v_fma_f32 v173, v173, s68, v7
  v_fma_f32 v174, v174, s68, v7
  v_fma_f32 v175, v175, s68, v7
  s_waitcnt lgkmcnt(1)
  v_mfma_f32_32x32x16_bf16 v[176:191], v[72:75], v[216:219], v[176:191]
  v_exp_f32 v172, v172
  v_exp_f32 v173, v173
  v_exp_f32 v174, v174
  v_exp_f32 v175, v175
  s_waitcnt lgkmcnt(0)
  v_mfma_f32_32x32x16_bf16 v[176:191], v[76:79], v[220:223], v[176:191]
  v_add_f32 v8, v8, v172
  v_add_f32 v8, v8, v173
  v_add_f32 v8, v8, v174
  v_add_f32 v8, v8, v175
  v_cvt_pk_bf16_f32 v166, v172, v173
  v_cvt_pk_bf16_f32 v167, v174, v175
  s_cmp_lt_u32 s3, 4
  s_cbranch_scc1 L_g904
  s_add_u32 m0, s14, 0
  s_nop 0
  buffer_load_dwordx4 v14, s[56:59], s13 offen offset:0 nt lds
  buffer_load_dwordx4 v14, s[56:59], s13 offen offset:1024 nt lds
  buffer_load_dwordx4 v14, s[56:59], s13 offen offset:2048 nt lds
  buffer_load_dwordx4 v14, s[56:59], s13 offen offset:3072 nt lds
  s_add_u32 s13, s13, 8192
  s_and_b32 s13, s13, 0x1ffff
L_g904:
  s_waitcnt vmcnt(8)
  s_barrier
  s_cmp_lt_u32 s3, 4
  s_cbranch_scc0 L_g916
  s_add_u32 m0, s14, 32768
  s_nop 0
  buffer_load_dwordx4 v22, s[52:55], s12 offen offset:0 nt lds
  buffer_load_dwordx4 v23, s[52:55], s12 offen offset:1024 nt lds
  buffer_load_dwordx4 v24, s[52:55], s12 offen offset:2048 nt lds
  buffer_load_dwordx4 v25, s[52:55], s12 offen offset:3072 nt lds
  s_add_u32 s12, s12, 8192
  s_and_b32 s12, s12, 0x1ffff
L_g916:
  v_xor_b32 v30, 0x10000, v30
  v_xor_b32 v31, 0x10000, v31
  v_xor_b32 v32, 0x10000, v32
  v_xor_b32 v33, 0x10000, v33
  ds_read_b64_tr_b16 v[48:49], v30 offset:0
  ds_read_b64_tr_b16 v[50:51], v30 offset:2048
  ds_read_b64_tr_b16 v[52:53], v31 offset:0
  ds_read_b64_tr_b16 v[54:55], v31 offset:2048
  ds_read_b64_tr_b16 v[56:57], v32 offset:0
  ds_read_b64_tr_b16 v[58:59], v32 offset:2048
  ds_read_b64_tr_b16 v[60:61], v33 offset:0
  ds_read_b64_tr_b16 v[62:63], v33 offset:2048
  ds_read_b64_tr_b16 v[64:65], v30 offset:4096
  ds_read_b64_tr_b16 v[66:67], v30 offset:6144
  ds_read_b64_tr_b16 v[68:69], v31 offset:4096
  ds_read_b64_tr_b16 v[70:71], v31 offset:6144
  ds_read_b64_tr_b16 v[72:73], v32 offset:4096
  ds_read_b64_tr_b16 v[74:75], v32 offset:6144
  ds_read_b64_tr_b16 v[76:77], v33 offset:4096
  ds_read_b64_tr_b16 v[78:79], v33 offset:6144
  v_max3_f32 v9, v176, v177, v178
  v_max3_f32 v9, v9, v179, v180
  v_max3_f32 v9, v9, v181, v182
  v_max3_f32 v9, v9, v183, v184
  v_max3_f32 v9, v9, v185, v186
  v_max3_f32 v9, v9, v187, v188
  v_max3_f32 v9, v9, v189, v190
  v_max_f32 v9, v9, v191
  s_waitcnt lgkmcnt(14)
  v_mfma_f32_32x32x16_bf16 v[96:111], v[48:51], v[160:163], 0
  v_mov_b32 v10, v9
  s_waitcnt lgkmcnt(12)
  v_mfma_f32_32x32x16_bf16 v[112:127], v[52:55], v[160:163], 0
  s_waitcnt lgkmcnt(10)
  v_mfma_f32_32x32x16_bf16 v[128:143], v[56:59], v[160:163], 0
  v_permlane32_swap_b32 v9, v10
  s_waitcnt lgkmcnt(8)
  v_mfma_f32_32x32x16_bf16 v[144:159], v[60:63], v[160:163], 0
  s_waitcnt lgkmcnt(6)
  v_mfma_f32_32x32x16_bf16 v[96:111], v[64:67], v[164:167], v[96:111]
  v_max_f32 v9, v9, v10
  s_waitcnt lgkmcnt(4)
  v_mfma_f32_32x32x16_bf16 v[112:127], v[68:71], v[164:167], v[112:127]
  s_waitcnt lgkmcnt(2)
  v_mfma_f32_32x32x16_bf16 v[128:143], v[72:75], v[164:167], v[128:143]
  v_mul_f32 v9, s68, v9
  s_waitcnt lgkmcnt(0)
  v_mfma_f32_32x32x16_bf16 v[144:159], v[76:79], v[164:167], v[144:159]
  s_cmp_lt_u32 s3, 4
  s_cbranch_scc1 L_g974
  s_add_u32 m0, s14, 32768
  s_nop 0
  buffer_load_dwordx4 v22, s[52:55], s12 offen offset:0 nt lds
  buffer_load_dwordx4 v23, s[52:55], s12 offen offset:1024 nt lds
  buffer_load_dwordx4 v24, s[52:55], s12 offen offset:2048 nt lds
  buffer_load_dwordx4 v25, s[52:55], s12 offen offset:3072 nt lds
  s_add_u32 s12, s12, 8192
  s_and_b32 s12, s12, 0x1ffff
L_g974:
  v_add_f32 v10, v9, v7
  v_cmp_lt_f32 vcc, 0x41000000, v10
  s_nop 7
  s_cbranch_vccz L_fast_987
  s_call_b64 s[80:81], L_slow
L_fast_987:
  s_waitcnt vmcnt(8)
  s_barrier
  s_cmp_lt_u32 s3, 4
  s_cbranch_scc0 L_g991
  s_add_u32 m0, s14, 65536
  s_nop 0
  buffer_load_dwordx4 v14, s[56:59], s13 offen offset:0 nt lds
  buffer_load_dwordx4 v14, s[56:59], s13 offen offset:1024 nt lds
  buffer_load_dwordx4 v14, s[56:59], s13 offen offset:2048 nt lds
  buffer_load_dwordx4 v14, s[56:59], s13 offen offset:3072 nt lds
  s_add_u32 s13, s13, 8192
  s_and_b32 s13, s13, 0x1ffff
L_g991:
  v_xor_b32 v34, 0x10000, v34
  ds_read_b128 v[48:51], v34 offset:32768
  v_xor_b32 v35, 0x10000, v35
  ds_read_b128 v[52:55], v35 offset:32768
  v_xor_b32 v36, 0x10000, v36
  ds_read_b128 v[56:59], v36 offset:32768
  v_xor_b32 v37, 0x10000, v37
  ds_read_b128 v[60:63], v37 offset:32768
  v_xor_b32 v38, 0x10000, v38
  ds_read_b128 v[64:67], v38 offset:32768
  v_xor_b32 v39, 0x10000, v39
  ds_read_b128 v[68:71], v39 offset:32768
  v_xor_b32 v40, 0x10000, v40
  ds_read_b128 v[72:75], v40 offset:32768
  v_xor_b32 v41, 0x10000, v41
  ds_read_b128 v[76:79], v41 offset:32768
  v_fma_f32 v176, v176, s68, v7
  v_fma_f32 v177, v177, s68, v7
  v_fma_f32 v178, v178, s68, v7
  v_fma_f32 v179, v179, s68, v7
  v_exp_f32 v176, v176
  v_exp_f32 v177, v177
  v_exp_f32 v178, v178
  v_exp_f32 v179, v179
  v_add_f32 v8, v8, v176
  v_add_f32 v8, v8, v177
  v_add_f32 v8, v8, v178
  v_add_f32 v8, v8, v179
  v_cvt_pk_bf16_f32 v176, v176, v177
  v_cvt_pk_bf16_f32 v177, v178, v179
  s_waitcnt lgkmcnt(7)
  v_mfma_f32_32x32x16_bf16 v[160:175], v[48:51], v[192:195], 0
  v_fma_f32 v180, v180, s68, v7
  v_fma_f32 v181, v181, s68, v7
  v_fma_f32 v182, v182, s68, v7
  v_fma_f32 v183, v183, s68, v7
  v_exp_f32 v180, v180
  s_waitcnt lgkmcnt(6)
  v_mfma_f32_32x32x16_bf16 v[160:175], v[52:55], v[196:199], v[160:175]
  v_exp_f32 v181, v181
  v_exp_f32 v182, v182
  v_exp_f32 v183, v183
  v_add_f32 v8, v8, v180
  v_add_f32 v8, v8, v181
  s_waitcnt lgkmcnt(5)
  v_mfma_f32_32x32x16_bf16 v[160:175], v[56:59], v[200:203], v[160:175]
  v_add_f32 v8, v8, v182
  v_add_f32 v8, v8, v183
  v_cvt_pk_bf16_f32 v178, v180, v181
  v_cvt_pk_bf16_f32 v179, v182, v183
  v_fma_f32 v184, v184, s68, v7
  v_fma_f32 v185, v185, s68, v7
  s_waitcnt lgkmcnt(4)
  v_mfma_f32_32x32x16_bf16 v[160:175], v[60:63], v[204:207], v[160:175]
  v_fma_f32 v186, v186, s68, v7
  v_fma_f32 v187, v187, s68, v7
  v_exp_f32 v184, v184
  v_exp_f32 v185, v185
  v_exp_f32 v186, v186
  s_waitcnt lgkmcnt(3)
  v_mfma_f32_32x32x16_bf16 v[160:175], v[64:67], v[208:211], v[160:175]
  v_exp_f32 v187, v187
  v_add_f32 v8, v8, v184
  v_add_f32 v8, v8, v185
  v_add_f32 v8, v8, v186
  v_add_f32 v8, v8, v187
  s_waitcnt lgkmcnt(2)
  v_mfma_f32_32x32x16_bf16 v[160:175], v[68:71], v[212:215], v[160:175]
  v_cvt_pk_bf16_f32 v180, v184, v185
  v_cvt_pk_bf16_f32 v181, v186, v187
  v_fma_f32 v188, v188, s68, v7
  v_fma_f32 v189, v189, s68, v7
  v_fma_f32 v190, v190, s68, v7
  v_fma_f32 v191, v191, s68, v7
  s_waitcnt lgkmcnt(1)
  v_mfma_f32_32x32x16_bf16 v[160:175], v[72:75], v[216:219], v[160:175]
  v_exp_f32 v188, v188
  v_exp_f32 v189, v189
  v_exp_f32 v190, v190
  v_exp_f32 v191, v191
  s_waitcnt lgkmcnt(0)
  v_mfma_f32_32x32x16_bf16 v[160:175], v[76:79], v[220:223], v[160:175]
  v_add_f32 v8, v8, v188
  v_add_f32 v8, v8, v189
  v_add_f32 v8, v8, v190
  v_add_f32 v8, v8, v191
  v_cvt_pk_bf16_f32 v182, v188, v189
  v_cvt_pk_bf16_f32 v183, v190, v191
  s_cmp_lt_u32 s3, 4
  s_cbranch_scc1 L_g1089
  s_add_u32 m0, s14, 65536
  s_nop 0
  buffer_load_dwordx4 v14, s[56:59], s13 offen offset:0 nt lds
  buffer_load_dwordx4 v14, s[56:59], s13 offen offset:1024 nt lds
  buffer_load_dwordx4 v14, s[56:59], s13 offen offset:2048 nt lds
  buffer_load_dwordx4 v14, s[56:59], s13 offen offset:3072 nt lds
  s_add_u32 s13, s13, 8192
  s_and_b32 s13, s13, 0x1ffff
L_g1089:
  s_waitcnt vmcnt(8)
  s_barrier
  s_cmp_lt_u32 s3, 4
  s_cbranch_scc0 L_g1101
  s_add_u32 m0, s14, 98304
  s_nop 0
  buffer_load_dwordx4 v22, s[52:55], s12 offen offset:0 nt lds
  buffer_load_dwordx4 v23, s[52:55], s12 offen offset:1024 nt lds
  buffer_load_dwordx4 v24, s[52:55], s12 offen offset:2048 nt lds
  buffer_load_dwordx4 v25, s[52:55], s12 offen offset:3072 nt lds
  s_add_u32 s12, s12, 8192
  s_and_b32 s12, s12, 0x1ffff
L_g1101:
  v_xor_b32 v30, 0x10000, v30
  v_xor_b32 v31, 0x10000, v31
  v_xor_b32 v32, 0x10000, v32
  v_xor_b32 v33, 0x10000, v33
  ds_read_b64_tr_b16 v[48:49], v30 offset:0
  ds_read_b64_tr_b16 v[50:51], v30 offset:2048
  ds_read_b64_tr_b16 v[52:53], v31 offset:0
  ds_read_b64_tr_b16 v[54:55], v31 offset:2048
  ds_read_b64_tr_b16 v[56:57], v32 offset:0
  ds_read_b64_tr_b16 v[58:59], v32 offset:2048
  ds_read_b64_tr_b16 v[60:61], v33 offset:0
  ds_read_b64_tr_b16 v[62:63], v33 offset:2048
  ds_read_b64_tr_b16 v[64:65], v30 offset:4096
  ds_read_b64_tr_b16 v[66:67], v30 offset:6144
  ds_read_b64_tr_b16 v[68:69], v31 offset:4096
  ds_read_b64_tr_b16 v[70:71], v31 offset:6144
  ds_read_b64_tr_b16 v[72:73], v32 offset:4096
  ds_read_b64_tr_b16 v[74:75], v32 offset:6144
  ds_read_b64_tr_b16 v[76:77], v33 offset:4096
  ds_read_b64_tr_b16 v[78:79], v33 offset:6144
  v_max3_f32 v9, v160, v161, v162
  v_max3_f32 v9, v9, v163, v164
  v_max3_f32 v9, v9, v165, v166
  v_max3_f32 v9, v9, v167, v168
  v_max3_f32 v9, v9, v169, v170
  v_max3_f32 v9, v9, v171, v172
  v_max3_f32 v9, v9, v173, v174
  v_max_f32 v9, v9, v175
  s_waitcnt lgkmcnt(14)
  v_mfma_f32_32x32x16_bf16 v[96:111], v[48:51], v[176:179], v[96:111]
  v_mov_b32 v10, v9
  s_waitcnt lgkmcnt(12)
  v_mfma_f32_32x32x16_bf16 v[112:127], v[52:55], v[176:179], v[112:127]
  s_waitcnt lgkmcnt(10)
  v_mfma_f32_32x32x16_bf16 v[128:143], v[56:59], v[176:179], v[128:143]
  v_permlane32_swap_b32 v9, v10
  s_waitcnt lgkmcnt(8)
  v_mfma_f32_32x32x16_bf16 v[144:159], v[60:63], v[176:179], v[144:159]
  s_waitcnt lgkmcnt(6)
  v_mfma_f32_32x32x16_bf16 v[96:111], v[64:67], v[180:183], v[96:111]
  v_max_f32 v9, v9, v10
  s_waitcnt lgkmcnt(4)
  v_mfma_f32_32x32x16_bf16 v[112:127], v[68:71], v[180:183], v[112:127]
  s_waitcnt lgkmcnt(2)
  v_mfma_f32_32x32x16_bf16 v[128:143], v[72:75], v[180:183], v[128:143]
  v_mul_f32 v9, s68, v9
  s_waitcnt lgkmcnt(0)
  v_mfma_f32_32x32x16_bf16 v[144:159], v[76:79], v[180:183], v[144:159]
  s_cmp_lt_u32 s3, 4
  s_cbranch_scc1 L_g1159
  s_add_u32 m0, s14, 98304
  s_nop 0
  buffer_load_dwordx4 v22, s[52:55], s12 offen offset:0 nt lds
  buffer_load_dwordx4 v23, s[52:55], s12 offen offset:1024 nt lds
  buffer_load_dwordx4 v24, s[52:55], s12 offen offset:2048 nt lds
  buffer_load_dwordx4 v25, s[52:55], s12 offen offset:3072 nt lds
  s_add_u32 s12, s12, 8192
  s_and_b32 s12, s12, 0x1ffff
L_g1159:
  v_add_f32 v10, v9, v7
  v_cmp_lt_f32 vcc, 0x41000000, v10
  s_nop 7
  s_cbranch_vccz L_fast_1172
  s_call_b64 s[80:81], L_slow
L_fast_1172:
  s_cmp_lg_u32 s3, 0
  s_cbranch_scc1 L_nonB
  s_waitcnt lgkmcnt(0)
  s_memrealtime s[100:101]
  s_waitcnt lgkmcnt(0)
  s_or_b32 s42, s100, 1
  s_mov_b64 exec, 1
  v_mov_b32 v16, s42
  v_mov_b32 v17, 0
  buffer_atomic_cmpswap v[16:17], v17, s[84:87], 0 offen offset:128 sc0 sc1
  s_mov_b64 exec, -1
  s_nop 1
L_nonB:
  s_mov_b32 s11, 5
  s_nop 1
L_attB:
  s_waitcnt vmcnt(8)
  s_barrier
  s_cmp_lt_u32 s3, 4
  s_cbranch_scc0 L_g1190
  s_add_u32 m0, s14, 0
  s_nop 0
  buffer_load_dwordx4 v14, s[56:59], s13 offen offset:0 nt lds
  buffer_load_dwordx4 v14, s[56:59], s13 offen offset:1024 nt lds
  buffer_load_dwordx4 v14, s[56:59], s13 offen offset:2048 nt lds
  buffer_load_dwordx4 v14, s[56:59], s13 offen offset:3072 nt lds
  s_add_u32 s13, s13, 8192
  s_and_b32 s13, s13, 0x1ffff
L_g1190:
  v_xor_b32 v34, 0x10000, v34
  ds_read_b128 v[48:51], v34 offset:32768
  v_xor_b32 v35, 0x10000, v35
  ds_read_b128 v[52:55], v35 offset:32768
  v_xor_b32 v36, 0x10000, v36
  ds_read_b128 v[56:59], v36 offset:32768
  v_xor_b32 v37, 0x10000, v37
  ds_read_b128 v[60:63], v37 offset:32768
  v_xor_b32 v38, 0x10000, v38
  ds_read_b128 v[64:67], v38 offset:32768
  v_xor_b32 v39, 0x10000, v39
  ds_read_b128 v[68:71], v39 offset:32768
  v_xor_b32 v40, 0x10000, v40
  ds_read_b128 v[72:75], v40 offset:32768
  v_xor_b32 v41, 0x10000, v41
  ds_read_b128 v[76:79], v41 offset:32768
  v_fma_f32 v160, v160, s68, v7
  v_fma_f32 v161, v161, s68, v7
  v_fma_f32 v162, v162, s68, v7
  v_fma_f32 v163, v163, s68, v7
  v_exp_f32 v160, v160
  v_exp_f32 v161, v161
  v_exp_f32 v162, v162
  v_exp_f32 v163, v163
  v_add_f32 v8, v8, v160
  v_add_f32 v8, v8, v161
  v_add_f32 v8, v8, v162
  v_add_f32 v8, v8, v163
  v_cvt_pk_bf16_f32 v160, v160, v161
  v_cvt_pk_bf16_f32 v161, v162, v163
  s_waitcnt lgkmcnt(7)
  v_mfma_f32_32x32x16_bf16 v[176:191], v[48:51], v[192:195], 0
  v_fma_f32 v164, v164, s68, v7
  v_fma_f32 v165, v165, s68, v7
  v_fma_f32 v166, v166, s68, v7
  v_fma_f32 v167, v167, s68, v7
  v_exp_f32 v164, v164
  s_waitcnt lgkmcnt(6)
  v_mfma_f32_32x32x16_bf16 v[176:191], v[52:55], v[196:199], v[176:191]
  v_exp_f32 v165, v165
  v_exp_f32 v166, v166
  v_exp_f32 v167, v167
  v_add_f32 v8, v8, v164
  v_add_f32 v8, v8, v165
  s_waitcnt lgkmcnt(5)
  v_mfma_f32_32x32x16_bf16 v[176:191], v[56:59], v[200:203], v[176:191]
  v_add_f32 v8, v8, v166
  v_add_f32 v8, v8, v167
  v_cvt_pk_bf16_f32 v162, v164, v165
  v_cvt_pk_bf16_f32 v163, v166, v167
  v_fma_f32 v168, v168, s68, v7
  v_fma_f32 v169, v169, s68, v7
  s_waitcnt lgkmcnt(4)
  v_mfma_f32_32x32x16_bf16 v[176:191], v[60:63], v[204:207], v[176:191]
  v_fma_f32 v170, v170, s68, v7
  v_fma_f32 v171, v171, s68, v7
  v_exp_f32 v168, v168
  v_exp_f32 v169, v169
  v_exp_f32 v170, v170
  s_waitcnt lgkmcnt(3)
  v_mfma_f32_32x32x16_bf16 v[176:191], v[64:67], v[208:211], v[176:191]
  v_exp_f32 v171, v171
  v_add_f32 v8, v8, v168
  v_add_f32 v8, v8, v169
  v_add_f32 v8, v8, v170
  v_add_f32 v8, v8, v171
  s_waitcnt lgkmcnt(2)
  v_mfma_f32_32x32x16_bf16 v[176:191], v[68:71], v[212:215], v[176:191]
  v_cvt_pk_bf16_f32 v164, v168, v169
  v_cvt_pk_bf16_f32 v165, v170, v171
  v_fma_f32 v172, v172, s68, v7
  v_fma_f32 v173, v173, s68, v7
  v_fma_f32 v174, v174, s68, v7
  v_fma_f32 v175, v175, s68, v7
  s_waitcnt lgkmcnt(1)
  v_mfma_f32_32x32x16_bf16 v[176:191], v[72:75], v[216:219], v[176:191]
  v_exp_f32 v172, v172
  v_exp_f32 v173, v173
  v_exp_f32 v174, v174
  v_exp_f32 v175, v175
  s_waitcnt lgkmcnt(0)
  v_mfma_f32_32x32x16_bf16 v[176:191], v[76:79], v[220:223], v[176:191]
  v_add_f32 v8, v8, v172
  v_add_f32 v8, v8, v173
  v_add_f32 v8, v8, v174
  v_add_f32 v8, v8, v175
  v_cvt_pk_bf16_f32 v166, v172, v173
  v_cvt_pk_bf16_f32 v167, v174, v175
  s_cmp_lt_u32 s3, 4
  s_cbranch_scc1 L_g1288
  s_add_u32 m0, s14, 0
  s_nop 0
  buffer_load_dwordx4 v14, s[56:59], s13 offen offset:0 nt lds
  buffer_load_dwordx4 v14, s[56:59], s13 offen offset:1024 nt lds
  buffer_load_dwordx4 v14, s[56:59], s13 offen offset:2048 nt lds
  buffer_load_dwordx4 v14, s[56:59], s13 offen offset:3072 nt lds
  s_add_u32 s13, s13, 8192
  s_and_b32 s13, s13, 0x1ffff
L_g1288:
  s_waitcnt vmcnt(8)
  s_barrier
  s_cmp_lt_u32 s3, 4
  s_cbranch_scc0 L_g1300
  s_add_u32 m0, s14, 32768
  s_nop 0
  buffer_load_dwordx4 v22, s[52:55], s12 offen offset:0 nt lds
  buffer_load_dwordx4 v23, s[52:55], s12 offen offset:1024 nt lds
  buffer_load_dwordx4 v24, s[52:55], s12 offen offset:2048 nt lds
  buffer_load_dwordx4 v25, s[52:55], s12 offen offset:3072 nt lds
  s_add_u32 s12, s12, 8192
  s_and_b32 s12, s12, 0x1ffff
L_g1300:
  v_xor_b32 v30, 0x10000, v30
  v_xor_b32 v31, 0x10000, v31
  v_xor_b32 v32, 0x10000, v32
  v_xor_b32 v33, 0x10000, v33
  ds_read_b64_tr_b16 v[48:49], v30 offset:0
  ds_read_b64_tr_b16 v[50:51], v30 offset:2048
  ds_read_b64_tr_b16 v[52:53], v31 offset:0
  ds_read_b64_tr_b16 v[54:55], v31 offset:2048
  ds_read_b64_tr_b16 v[56:57], v32 offset:0
  ds_read_b64_tr_b16 v[58:59], v32 offset:2048
  ds_read_b64_tr_b16 v[60:61], v33 offset:0
  ds_read_b64_tr_b16 v[62:63], v33 offset:2048
  ds_read_b64_tr_b16 v[64:65], v30 offset:4096
  ds_read_b64_tr_b16 v[66:67], v30 offset:6144
  ds_read_b64_tr_b16 v[68:69], v31 offset:4096
  ds_read_b64_tr_b16 v[70:71], v31 offset:6144
  ds_read_b64_tr_b16 v[72:73], v32 offset:4096
  ds_read_b64_tr_b16 v[74:75], v32 offset:6144
  ds_read_b64_tr_b16 v[76:77], v33 offset:4096
  ds_read_b64_tr_b16 v[78:79], v33 offset:6144
  v_max3_f32 v9, v176, v177, v178
  v_max3_f32 v9, v9, v179, v180
  v_max3_f32 v9, v9, v181, v182
  v_max3_f32 v9, v9, v183, v184
  v_max3_f32 v9, v9, v185, v186
  v_max3_f32 v9, v9, v187, v188
  v_max3_f32 v9, v9, v189, v190
  v_max_f32 v9, v9, v191
  s_waitcnt lgkmcnt(14)
  v_mfma_f32_32x32x16_bf16 v[96:111], v[48:51], v[160:163], v[96:111]
  v_mov_b32 v10, v9
  s_waitcnt lgkmcnt(12)
  v_mfma_f32_32x32x16_bf16 v[112:127], v[52:55], v[160:163], v[112:127]
  s_waitcnt lgkmcnt(10)
  v_mfma_f32_32x32x16_bf16 v[128:143], v[56:59], v[160:163], v[128:143]
  v_permlane32_swap_b32 v9, v10
  s_waitcnt lgkmcnt(8)
  v_mfma_f32_32x32x16_bf16 v[144:159], v[60:63], v[160:163], v[144:159]
  s_waitcnt lgkmcnt(6)
  v_mfma_f32_32x32x16_bf16 v[96:111], v[64:67], v[164:167], v[96:111]
  v_max_f32 v9, v9, v10
  s_waitcnt lgkmcnt(4)
  v_mfma_f32_32x32x16_bf16 v[112:127], v[68:71], v[164:167], v[112:127]
  s_waitcnt lgkmcnt(2)
  v_mfma_f32_32x32x16_bf16 v[128:143], v[72:75], v[164:167], v[128:143]
  v_mul_f32 v9, s68, v9
  s_waitcnt lgkmcnt(0)
  v_mfma_f32_32x32x16_bf16 v[144:159], v[76:79], v[164:167], v[144:159]
  s_cmp_lt_u32 s3, 4
  s_cbranch_scc1 L_g1358
  s_add_u32 m0, s14, 32768
  s_nop 0
  buffer_load_dwordx4 v22, s[52:55], s12 offen offset:0 nt lds
  buffer_load_dwordx4 v23, s[52:55], s12 offen offset:1024 nt lds
  buffer_load_dwordx4 v24, s[52:55], s12 offen offset:2048 nt lds
  buffer_load_dwordx4 v25, s[52:55], s12 offen offset:3072 nt lds
  s_add_u32 s12, s12, 8192
  s_and_b32 s12, s12, 0x1ffff
L_g1358:
  v_add_f32 v10, v9, v7
  v_cmp_lt_f32 vcc, 0x41000000, v10
  s_nop 7
  s_cbranch_vccz L_fast_1371
  s_call_b64 s[80:81], L_slow
L_fast_1371:
  s_waitcnt vmcnt(8)
  s_barrier
  s_cmp_lt_u32 s3, 4
  s_cbranch_scc0 L_g1375
  s_add_u32 m0, s14, 65536
  s_nop 0
  buffer_load_dwordx4 v14, s[56:59], s13 offen offset:0 nt lds
  buffer_load_dwordx4 v14, s[56:59], s13 offen offset:1024 nt lds
  buffer_load_dwordx4 v14, s[56:59], s13 offen offset:2048 nt lds
  buffer_load_dwordx4 v14, s[56:59], s13 offen offset:3072 nt lds
  s_add_u32 s13, s13, 8192
  s_and_b32 s13, s13, 0x1ffff
L_g1375:
  v_xor_b32 v34, 0x10000, v34
  ds_read_b128 v[48:51], v34 offset:32768
  v_xor_b32 v35, 0x10000, v35
  ds_read_b128 v[52:55], v35 offset:32768
  v_xor_b32 v36, 0x10000, v36
  ds_read_b128 v[56:59], v36 offset:32768
  v_xor_b32 v37, 0x10000, v37
  ds_read_b128 v[60:63], v37 offset:32768
  v_xor_b32 v38, 0x10000, v38
  ds_read_b128 v[64:67], v38 offset:32768
  v_xor_b32 v39, 0x10000, v39
  ds_read_b128 v[68:71], v39 offset:32768
  v_xor_b32 v40, 0x10000, v40
  ds_read_b128 v[72:75], v40 offset:32768
  v_xor_b32 v41, 0x10000, v41
  ds_read_b128 v[76:79], v41 offset:32768
  v_fma_f32 v176, v176, s68, v7
  v_fma_f32 v177, v177, s68, v7
  v_fma_f32 v178, v178, s68, v7
  v_fma_f32 v179, v179, s68, v7
  v_exp_f32 v176, v176
  v_exp_f32 v177, v177
  v_exp_f32 v178, v178
  v_exp_f32 v179, v179
  v_add_f32 v8, v8, v176
  v_add_f32 v8, v8, v177
  v_add_f32 v8, v8, v178
  v_add_f32 v8, v8, v179
  v_cvt_pk_bf16_f32 v176, v176, v177
  v_cvt_pk_bf16_f32 v177, v178, v179
  s_waitcnt lgkmcnt(7)
  v_mfma_f32_32x32x16_bf16 v[160:175], v[48:51], v[192:195], 0
  v_fma_f32 v180, v180, s68, v7
  v_fma_f32 v181, v181, s68, v7
  v_fma_f32 v182, v182, s68, v7
  v_fma_f32 v183, v183, s68, v7
  v_exp_f32 v180, v180
  s_waitcnt lgkmcnt(6)
  v_mfma_f32_32x32x16_bf16 v[160:175], v[52:55], v[196:199], v[160:175]
  v_exp_f32 v181, v181
  v_exp_f32 v182, v182
  v_exp_f32 v183, v183
  v_add_f32 v8, v8, v180
  v_add_f32 v8, v8, v181
  s_waitcnt lgkmcnt(5)
  v_mfma_f32_32x32x16_bf16 v[160:175], v[56:59], v[200:203], v[160:175]
  v_add_f32 v8, v8, v182
  v_add_f32 v8, v8, v183
  v_cvt_pk_bf16_f32 v178, v180, v181
  v_cvt_pk_bf16_f32 v179, v182, v183
  v_fma_f32 v184, v184, s68, v7
  v_fma_f32 v185, v185, s68, v7
  s_waitcnt lgkmcnt(4)
  v_mfma_f32_32x32x16_bf16 v[160:175], v[60:63], v[204:207], v[160:175]
  v_fma_f32 v186, v186, s68, v7
  v_fma_f32 v187, v187, s68, v7
  v_exp_f32 v184, v184
  v_exp_f32 v185, v185
  v_exp_f32 v186, v186
  s_waitcnt lgkmcnt(3)
  v_mfma_f32_32x32x16_bf16 v[160:175], v[64:67], v[208:211], v[160:175]
  v_exp_f32 v187, v187
  v_add_f32 v8, v8, v184
  v_add_f32 v8, v8, v185
  v_add_f32 v8, v8, v186
  v_add_f32 v8, v8, v187
  s_waitcnt lgkmcnt(2)
  v_mfma_f32_32x32x16_bf16 v[160:175], v[68:71], v[212:215], v[160:175]
  v_cvt_pk_bf16_f32 v180, v184, v185
  v_cvt_pk_bf16_f32 v181, v186, v187
  v_fma_f32 v188, v188, s68, v7
  v_fma_f32 v189, v189, s68, v7
  v_fma_f32 v190, v190, s68, v7
  v_fma_f32 v191, v191, s68, v7
  s_waitcnt lgkmcnt(1)
  v_mfma_f32_32x32x16_bf16 v[160:175], v[72:75], v[216:219], v[160:175]
  v_exp_f32 v188, v188
  v_exp_f32 v189, v189
  v_exp_f32 v190, v190
  v_exp_f32 v191, v191
  s_waitcnt lgkmcnt(0)
  v_mfma_f32_32x32x16_bf16 v[160:175], v[76:79], v[220:223], v[160:175]
  v_add_f32 v8, v8, v188
  v_add_f32 v8, v8, v189
  v_add_f32 v8, v8, v190
  v_add_f32 v8, v8, v191
  v_cvt_pk_bf16_f32 v182, v188, v189
  v_cvt_pk_bf16_f32 v183, v190, v191
  s_cmp_lt_u32 s3, 4
  s_cbranch_scc1 L_g1473
  s_add_u32 m0, s14, 65536
  s_nop 0
  buffer_load_dwordx4 v14, s[56:59], s13 offen offset:0 nt lds
  buffer_load_dwordx4 v14, s[56:59], s13 offen offset:1024 nt lds
  buffer_load_dwordx4 v14, s[56:59], s13 offen offset:2048 nt lds
  buffer_load_dwordx4 v14, s[56:59], s13 offen offset:3072 nt lds
  s_add_u32 s13, s13, 8192
  s_and_b32 s13, s13, 0x1ffff
L_g1473:
  s_waitcnt vmcnt(8)
  s_barrier
  s_cmp_lt_u32 s3, 4
  s_cbranch_scc0 L_g1485
  s_add_u32 m0, s14, 98304
  s_nop 0
  buffer_load_dwordx4 v22, s[52:55], s12 offen offset:0 nt lds
  buffer_load_dwordx4 v23, s[52:55], s12 offen offset:1024 nt lds
  buffer_load_dwordx4 v24, s[52:55], s12 offen offset:2048 nt lds
  buffer_load_dwordx4 v25, s[52:55], s12 offen offset:3072 nt lds
  s_add_u32 s12, s12, 8192
  s_and_b32 s12, s12, 0x1ffff
L_g1485:
  v_xor_b32 v30, 0x10000, v30
  v_xor_b32 v31, 0x10000, v31
  v_xor_b32 v32, 0x10000, v32
  v_xor_b32 v33, 0x10000, v33
  ds_read_b64_tr_b16 v[48:49], v30 offset:0
  ds_read_b64_tr_b16 v[50:51], v30 offset:2048
  ds_read_b64_tr_b16 v[52:53], v31 offset:0
  ds_read_b64_tr_b16 v[54:55], v31 offset:2048
  ds_read_b64_tr_b16 v[56:57], v32 offset:0
  ds_read_b64_tr_b16 v[58:59], v32 offset:2048
  ds_read_b64_tr_b16 v[60:61], v33 offset:0
  ds_read_b64_tr_b16 v[62:63], v33 offset:2048
  ds_read_b64_tr_b16 v[64:65], v30 offset:4096
  ds_read_b64_tr_b16 v[66:67], v30 offset:6144
  ds_read_b64_tr_b16 v[68:69], v31 offset:4096
  ds_read_b64_tr_b16 v[70:71], v31 offset:6144
  ds_read_b64_tr_b16 v[72:73], v32 offset:4096
  ds_read_b64_tr_b16 v[74:75], v32 offset:6144
  ds_read_b64_tr_b16 v[76:77], v33 offset:4096
  ds_read_b64_tr_b16 v[78:79], v33 offset:6144
  v_max3_f32 v9, v160, v161, v162
  v_max3_f32 v9, v9, v163, v164
  v_max3_f32 v9, v9, v165, v166
  v_max3_f32 v9, v9, v167, v168
  v_max3_f32 v9, v9, v169, v170
  v_max3_f32 v9, v9, v171, v172
  v_max3_f32 v9, v9, v173, v174
  v_max_f32 v9, v9, v175
  s_waitcnt lgkmcnt(14)
  v_mfma_f32_32x32x16_bf16 v[96:111], v[48:51], v[176:179], v[96:111]
  v_mov_b32 v10, v9
  s_waitcnt lgkmcnt(12)
  v_mfma_f32_32x32x16_bf16 v[112:127], v[52:55], v[176:179], v[112:127]
  s_waitcnt lgkmcnt(10)
  v_mfma_f32_32x32x16_bf16 v[128:143], v[56:59], v[176:179], v[128:143]
  v_permlane32_swap_b32 v9, v10
  s_waitcnt lgkmcnt(8)
  v_mfma_f32_32x32x16_bf16 v[144:159], v[60:63], v[176:179], v[144:159]
  s_waitcnt lgkmcnt(6)
  v_mfma_f32_32x32x16_bf16 v[96:111], v[64:67], v[180:183], v[96:111]
  v_max_f32 v9, v9, v10
  s_waitcnt lgkmcnt(4)
  v_mfma_f32_32x32x16_bf16 v[112:127], v[68:71], v[180:183], v[112:127]
  s_waitcnt lgkmcnt(2)
  v_mfma_f32_32x32x16_bf16 v[128:143], v[72:75], v[180:183], v[128:143]
  v_mul_f32 v9, s68, v9
  s_waitcnt lgkmcnt(0)
  v_mfma_f32_32x32x16_bf16 v[144:159], v[76:79], v[180:183], v[144:159]
  s_cmp_lt_u32 s3, 4
  s_cbranch_scc1 L_g1543
  s_add_u32 m0, s14, 98304
  s_nop 0
  buffer_load_dwordx4 v22, s[52:55], s12 offen offset:0 nt lds
  buffer_load_dwordx4 v23, s[52:55], s12 offen offset:1024 nt lds
  buffer_load_dwordx4 v24, s[52:55], s12 offen offset:2048 nt lds
  buffer_load_dwordx4 v25, s[52:55], s12 offen offset:3072 nt lds
  s_add_u32 s12, s12, 8192
  s_and_b32 s12, s12, 0x1ffff
L_g1543:
  v_add_f32 v10, v9, v7
  v_cmp_lt_f32 vcc, 0x41000000, v10
  s_nop 7
  s_cbranch_vccz L_fast_1556
  s_call_b64 s[80:81], L_slow
L_fast_1556:
  s_sub_u32 s11, s11, 1
  s_cmp_lg_u32 s11, 0
  s_nop 1
  s_cbranch_scc1 L_attB
  s_waitcnt vmcnt(8)
  s_barrier
  s_cmp_lt_u32 s3, 4
  s_cbranch_scc0 L_g1564
  s_add_u32 m0, s14, 0
  s_nop 0
  buffer_load_dwordx4 v14, s[56:59], s13 offen offset:0 nt lds
  buffer_load_dwordx4 v14, s[56:59], s13 offen offset:1024 nt lds
  buffer_load_dwordx4 v14, s[56:59], s13 offen offset:2048 nt lds
  buffer_load_dwordx4 v14, s[56:59], s13 offen offset:3072 nt lds
  s_add_u32 s13, s13, 8192
  s_and_b32 s13, s13, 0x1ffff
L_g1564:
  v_xor_b32 v34, 0x10000, v34
  ds_read_b128 v[48:51], v34 offset:32768
  v_xor_b32 v35, 0x10000, v35
  ds_read_b128 v[52:55], v35 offset:32768
  v_xor_b32 v36, 0x10000, v36
  ds_read_b128 v[56:59], v36 offset:32768
  v_xor_b32 v37, 0x10000, v37
  ds_read_b128 v[60:63], v37 offset:32768
  v_xor_b32 v38, 0x10000, v38
  ds_read_b128 v[64:67], v38 offset:32768
  v_xor_b32 v39, 0x10000, v39
  ds_read_b128 v[68:71], v39 offset:32768
  v_xor_b32 v40, 0x10000, v40
  ds_read_b128 v[72:75], v40 offset:32768
  v_xor_b32 v41, 0x10000, v41
  ds_read_b128 v[76:79], v41 offset:32768
  v_fma_f32 v160, v160, s68, v7
  v_fma_f32 v161, v161, s68, v7
  v_fma_f32 v162, v162, s68, v7
  v_fma_f32 v163, v163, s68, v7
  v_exp_f32 v160, v160
  v_exp_f32 v161, v161
  v_exp_f32 v162, v162
  v_exp_f32 v163, v163
  v_add_f32 v8, v8, v160
  v_add_f32 v8, v8, v161
  v_add_f32 v8, v8, v162
  v_add_f32 v8, v8, v163
  v_cvt_pk_bf16_f32 v160, v160, v161
  v_cvt_pk_bf16_f32 v161, v162, v163
  s_waitcnt lgkmcnt(7)
  v_mfma_f32_32x32x16_bf16 v[176:191], v[48:51], v[192:195], 0
  v_fma_f32 v164, v164, s68, v7
  v_fma_f32 v165, v165, s68, v7
  v_fma_f32 v166, v166, s68, v7
  v_fma_f32 v167, v167, s68, v7
  v_exp_f32 v164, v164
  s_waitcnt lgkmcnt(6)
  v_mfma_f32_32x32x16_bf16 v[176:191], v[52:55], v[196:199], v[176:191]
  v_exp_f32 v165, v165
  v_exp_f32 v166, v166
  v_exp_f32 v167, v167
  v_add_f32 v8, v8, v164
  v_add_f32 v8, v8, v165
  s_waitcnt lgkmcnt(5)
  v_mfma_f32_32x32x16_bf16 v[176:191], v[56:59], v[200:203], v[176:191]
  v_add_f32 v8, v8, v166
  v_add_f32 v8, v8, v167
  v_cvt_pk_bf16_f32 v162, v164, v165
  v_cvt_pk_bf16_f32 v163, v166, v167
  v_fma_f32 v168, v168, s68, v7
  v_fma_f32 v169, v169, s68, v7
  s_waitcnt lgkmcnt(4)
  v_mfma_f32_32x32x16_bf16 v[176:191], v[60:63], v[204:207], v[176:191]
  v_fma_f32 v170, v170, s68, v7
  v_fma_f32 v171, v171, s68, v7
  v_exp_f32 v168, v168
  v_exp_f32 v169, v169
  v_exp_f32 v170, v170
  s_waitcnt lgkmcnt(3)
  v_mfma_f32_32x32x16_bf16 v[176:191], v[64:67], v[208:211], v[176:191]
  v_exp_f32 v171, v171
  v_add_f32 v8, v8, v168
  v_add_f32 v8, v8, v169
  v_add_f32 v8, v8, v170
  v_add_f32 v8, v8, v171
  s_waitcnt lgkmcnt(2)
  v_mfma_f32_32x32x16_bf16 v[176:191], v[68:71], v[212:215], v[176:191]
  v_cvt_pk_bf16_f32 v164, v168, v169
  v_cvt_pk_bf16_f32 v165, v170, v171
  v_fma_f32 v172, v172, s68, v7
  v_fma_f32 v173, v173, s68, v7
  v_fma_f32 v174, v174, s68, v7
  v_fma_f32 v175, v175, s68, v7
  s_waitcnt lgkmcnt(1)
  v_mfma_f32_32x32x16_bf16 v[176:191], v[72:75], v[216:219], v[176:191]
  v_exp_f32 v172, v172
  v_exp_f32 v173, v173
  v_exp_f32 v174, v174
  v_exp_f32 v175, v175
  s_waitcnt lgkmcnt(0)
  v_mfma_f32_32x32x16_bf16 v[176:191], v[76:79], v[220:223], v[176:191]
  v_add_f32 v8, v8, v172
  v_add_f32 v8, v8, v173
  v_add_f32 v8, v8, v174
  v_add_f32 v8, v8, v175
  v_cvt_pk_bf16_f32 v166, v172, v173
  v_cvt_pk_bf16_f32 v167, v174, v175
  s_cmp_lt_u32 s3, 4
  s_cbranch_scc1 L_g1662
  s_add_u32 m0, s14, 0
  s_nop 0
  buffer_load_dwordx4 v14, s[56:59], s13 offen offset:0 nt lds
  buffer_load_dwordx4 v14, s[56:59], s13 offen offset:1024 nt lds
  buffer_load_dwordx4 v14, s[56:59], s13 offen offset:2048 nt lds
  buffer_load_dwordx4 v14, s[56:59], s13 offen offset:3072 nt lds
  s_add_u32 s13, s13, 8192
  s_and_b32 s13, s13, 0x1ffff
L_g1662:
  s_waitcnt vmcnt(8)
  s_barrier
  s_cmp_lt_u32 s3, 4
  s_cbranch_scc0 L_g1674
  s_add_u32 m0, s14, 32768
  s_nop 0
  buffer_load_dwordx4 v22, s[52:55], s12 offen offset:0 nt lds
  buffer_load_dwordx4 v23, s[52:55], s12 offen offset:1024 nt lds
  buffer_load_dwordx4 v24, s[52:55], s12 offen offset:2048 nt lds
  buffer_load_dwordx4 v25, s[52:55], s12 offen offset:3072 nt lds
  s_add_u32 s12, s12, 8192
  s_and_b32 s12, s12, 0x1ffff
L_g1674:
  v_xor_b32 v30, 0x10000, v30
  v_xor_b32 v31, 0x10000, v31
  v_xor_b32 v32, 0x10000, v32
  v_xor_b32 v33, 0x10000, v33
  ds_read_b64_tr_b16 v[48:49], v30 offset:0
  ds_read_b64_tr_b16 v[50:51], v30 offset:2048
  ds_read_b64_tr_b16 v[52:53], v31 offset:0
  ds_read_b64_tr_b16 v[54:55], v31 offset:2048
  ds_read_b64_tr_b16 v[56:57], v32 offset:0
  ds_read_b64_tr_b16 v[58:59], v32 offset:2048
  ds_read_b64_tr_b16 v[60:61], v33 offset:0
  ds_read_b64_tr_b16 v[62:63], v33 offset:2048
  ds_read_b64_tr_b16 v[64:65], v30 offset:4096
  ds_read_b64_tr_b16 v[66:67], v30 offset:6144
  ds_read_b64_tr_b16 v[68:69], v31 offset:4096
  ds_read_b64_tr_b16 v[70:71], v31 offset:6144
  ds_read_b64_tr_b16 v[72:73], v32 offset:4096
  ds_read_b64_tr_b16 v[74:75], v32 offset:6144
  ds_read_b64_tr_b16 v[76:77], v33 offset:4096
  ds_read_b64_tr_b16 v[78:79], v33 offset:6144
  v_max3_f32 v9, v176, v177, v178
  v_max3_f32 v9, v9, v179, v180
  v_max3_f32 v9, v9, v181, v182
  v_max3_f32 v9, v9, v183, v184
  v_max3_f32 v9, v9, v185, v186
  v_max3_f32 v9, v9, v187, v188
  v_max3_f32 v9, v9, v189, v190
  v_max_f32 v9, v9, v191
  s_waitcnt lgkmcnt(14)
  v_mfma_f32_32x32x16_bf16 v[96:111], v[48:51], v[160:163], v[96:111]
  v_mov_b32 v10, v9
  s_waitcnt lgkmcnt(12)
  v_mfma_f32_32x32x16_bf16 v[112:127], v[52:55], v[160:163], v[112:127]
  s_waitcnt lgkmcnt(10)
  v_mfma_f32_32x32x16_bf16 v[128:143], v[56:59], v[160:163], v[128:143]
  v_permlane32_swap_b32 v9, v10
  s_waitcnt lgkmcnt(8)
  v_mfma_f32_32x32x16_bf16 v[144:159], v[60:63], v[160:163], v[144:159]
  s_waitcnt lgkmcnt(6)
  v_mfma_f32_32x32x16_bf16 v[96:111], v[64:67], v[164:167], v[96:111]
  v_max_f32 v9, v9, v10
  s_waitcnt lgkmcnt(4)
  v_mfma_f32_32x32x16_bf16 v[112:127], v[68:71], v[164:167], v[112:127]
  s_waitcnt lgkmcnt(2)
  v_mfma_f32_32x32x16_bf16 v[128:143], v[72:75], v[164:167], v[128:143]
  v_mul_f32 v9, s68, v9
  s_waitcnt lgkmcnt(0)
  v_mfma_f32_32x32x16_bf16 v[144:159], v[76:79], v[164:167], v[144:159]
  s_cmp_lt_u32 s3, 4
  s_cbranch_scc1 L_g1732
  s_add_u32 m0, s14, 32768
  s_nop 0
  buffer_load_dwordx4 v22, s[52:55], s12 offen offset:0 nt lds
  buffer_load_dwordx4 v23, s[52:55], s12 offen offset:1024 nt lds
  buffer_load_dwordx4 v24, s[52:55], s12 offen offset:2048 nt lds
  buffer_load_dwordx4 v25, s[52:55], s12 offen offset:3072 nt lds
  s_add_u32 s12, s12, 8192
  s_and_b32 s12, s12, 0x1ffff
L_g1732:
  v_add_f32 v10, v9, v7
  v_cmp_lt_f32 vcc, 0x41000000, v10
  s_nop 7
  s_cbranch_vccz L_fast_1745
  s_call_b64 s[80:81], L_slow
L_fast_1745:
  s_mov_b32 s10, s4
  s_mov_b32 s78, s4
  s_lshl_b32 s77, s5, 19
  s_add_u32 s77, s77, s75
  v_xor_b32 v18, 0, v2
  v_xor_b32 v19, 64, v2
  v_xor_b32 v20, 128, v2
  v_xor_b32 v21, 192, v2
  s_waitcnt vmcnt(8)
  s_barrier
  s_cmp_lt_u32 s3, 4
  s_cbranch_scc0 L_g1757
  s_add_u32 m0, s14, 65536
  s_nop 0
  buffer_load_dwordx4 v14, s[56:59], s13 offen offset:0 nt lds
  buffer_load_dwordx4 v14, s[56:59], s13 offen offset:1024 nt lds
  buffer_load_dwordx4 v14, s[56:59], s13 offen offset:2048 nt lds
  buffer_load_dwordx4 v14, s[56:59], s13 offen offset:3072 nt lds
  s_add_u32 s13, s13, 8192
  s_and_b32 s13, s13, 0x1ffff
L_g1757:
  v_xor_b32 v34, 0x10000, v34
  ds_read_b128 v[48:51], v34 offset:32768
  v_xor_b32 v35, 0x10000, v35
  ds_read_b128 v[52:55], v35 offset:32768
  v_xor_b32 v36, 0x10000, v36
  ds_read_b128 v[56:59], v36 offset:32768
  v_xor_b32 v37, 0x10000, v37
  ds_read_b128 v[60:63], v37 offset:32768
  v_xor_b32 v38, 0x10000, v38
  ds_read_b128 v[64:67], v38 offset:32768
  v_xor_b32 v39, 0x10000, v39
  ds_read_b128 v[68:71], v39 offset:32768
  v_xor_b32 v40, 0x10000, v40
  ds_read_b128 v[72:75], v40 offset:32768
  v_xor_b32 v41, 0x10000, v41
  ds_read_b128 v[76:79], v41 offset:32768
  v_fma_f32 v176, v176, s68, v7
  v_fma_f32 v177, v177, s68, v7
  v_fma_f32 v178, v178, s68, v7
  v_fma_f32 v179, v179, s68, v7
  v_exp_f32 v176, v176
  v_exp_f32 v177, v177
  v_exp_f32 v178, v178
  v_exp_f32 v179, v179
  v_add_f32 v8, v8, v176
  v_add_f32 v8, v8, v177
  v_add_f32 v8, v8, v178
  v_add_f32 v8, v8, v179
  v_cvt_pk_bf16_f32 v176, v176, v177
  v_cvt_pk_bf16_f32 v177, v178, v179
  s_waitcnt lgkmcnt(7)
  v_mfma_f32_32x32x16_bf16 v[160:175], v[48:51], v[192:195], 0
  v_fma_f32 v180, v180, s68, v7
  v_fma_f32 v181, v181, s68, v7
  v_fma_f32 v182, v182, s68, v7
  v_fma_f32 v183, v183, s68, v7
  v_exp_f32 v180, v180
  s_waitcnt lgkmcnt(6)
  v_mfma_f32_32x32x16_bf16 v[160:175], v[52:55], v[196:199], v[160:175]
  v_exp_f32 v181, v181
  v_exp_f32 v182, v182
  v_exp_f32 v183, v183
  v_add_f32 v8, v8, v180
  v_add_f32 v8, v8, v181
  s_waitcnt lgkmcnt(5)
  v_mfma_f32_32x32x16_bf16 v[160:175], v[56:59], v[200:203], v[160:175]
  v_add_f32 v8, v8, v182
  v_add_f32 v8, v8, v183
  v_cvt_pk_bf16_f32 v178, v180, v181
  v_cvt_pk_bf16_f32 v179, v182, v183
  v_fma_f32 v184, v184, s68, v7
  v_fma_f32 v185, v185, s68, v7
  s_waitcnt lgkmcnt(4)
  v_mfma_f32_32x32x16_bf16 v[160:175], v[60:63], v[204:207], v[160:175]
  v_fma_f32 v186, v186, s68, v7
  v_fma_f32 v187, v187, s68, v7
  v_exp_f32 v184, v184
  v_exp_f32 v185, v185
  v_exp_f32 v186, v186
  s_waitcnt lgkmcnt(3)
  v_mfma_f32_32x32x16_bf16 v[160:175], v[64:67], v[208:211], v[160:175]
  v_exp_f32 v187, v187
  v_add_f32 v8, v8, v184
  v_add_f32 v8, v8, v185
  v_add_f32 v8, v8, v186
  v_add_f32 v8, v8, v187
  s_waitcnt lgkmcnt(2)
  v_mfma_f32_32x32x16_bf16 v[160:175], v[68:71], v[212:215], v[160:175]
  v_cvt_pk_bf16_f32 v180, v184, v185
  v_cvt_pk_bf16_f32 v181, v186, v187
  v_fma_f32 v188, v188, s68, v7
  v_fma_f32 v189, v189, s68, v7
  v_fma_f32 v190, v190, s68, v7
  v_fma_f32 v191, v191, s68, v7
  s_waitcnt lgkmcnt(1)
  v_mfma_f32_32x32x16_bf16 v[160:175], v[72:75], v[216:219], v[160:175]
  v_exp_f32 v188, v188
  v_exp_f32 v189, v189
  v_exp_f32 v190, v190
  v_exp_f32 v191, v191
  s_waitcnt lgkmcnt(0)
  v_mfma_f32_32x32x16_bf16 v[160:175], v[76:79], v[220:223], v[160:175]
  v_add_f32 v8, v8, v188
  v_add_f32 v8, v8, v189
  v_add_f32 v8, v8, v190
  v_add_f32 v8, v8, v191
  v_cvt_pk_bf16_f32 v182, v188, v189
  v_cvt_pk_bf16_f32 v183, v190, v191
  s_cmp_lt_u32 s3, 4
  s_cbranch_scc1 L_g1855
  s_add_u32 m0, s14, 65536
  s_nop 0
  buffer_load_dwordx4 v14, s[56:59], s13 offen offset:0 nt lds
  buffer_load_dwordx4 v14, s[56:59], s13 offen offset:1024 nt lds
  buffer_load_dwordx4 v14, s[56:59], s13 offen offset:2048 nt lds
  buffer_load_dwordx4 v14, s[56:59], s13 offen offset:3072 nt lds
  s_add_u32 s13, s13, 8192
  s_and_b32 s13, s13, 0x1ffff
L_g1855:
  s_waitcnt vmcnt(8)
  s_barrier
  s_cmp_lt_u32 s3, 4
  s_cbranch_scc0 L_g1867
  s_add_u32 m0, s14, 98304
  s_nop 0
  buffer_load_dwordx4 v14, s[56:59], s13 offen offset:0 nt lds
  buffer_load_dwordx4 v14, s[56:59], s13 offen offset:1024 nt lds
  buffer_load_dwordx4 v14, s[56:59], s13 offen offset:2048 nt lds
  buffer_load_dwordx4 v14, s[56:59], s13 offen offset:3072 nt lds
  s_add_u32 s13, s13, 8192
  s_and_b32 s13, s13, 0x1ffff
L_g1867:
  v_xor_b32 v30, 0x10000, v30
  v_xor_b32 v31, 0x10000, v31
  v_xor_b32 v32, 0x10000, v32
  v_xor_b32 v33, 0x10000, v33
  ds_read_b64_tr_b16 v[48:49], v30 offset:0
  ds_read_b64_tr_b16 v[50:51], v30 offset:2048
  ds_read_b64_tr_b16 v[52:53], v31 offset:0
  ds_read_b64_tr_b16 v[54:55], v31 offset:2048
  ds_read_b64_tr_b16 v[56:57], v32 offset:0
  ds_read_b64_tr_b16 v[58:59], v32 offset:2048
  ds_read_b64_tr_b16 v[60:61], v33 offset:0
  ds_read_b64_tr_b16 v[62:63], v33 offset:2048
  ds_read_b64_tr_b16 v[64:65], v30 offset:4096
  ds_read_b64_tr_b16 v[66:67], v30 offset:6144
  ds_read_b64_tr_b16 v[68:69], v31 offset:4096
  ds_read_b64_tr_b16 v[70:71], v31 offset:6144
  ds_read_b64_tr_b16 v[72:73], v32 offset:4096
  ds_read_b64_tr_b16 v[74:75], v32 offset:6144
  ds_read_b64_tr_b16 v[76:77], v33 offset:4096
  ds_read_b64_tr_b16 v[78:79], v33 offset:6144
  v_max3_f32 v9, v160, v161, v162
  v_max3_f32 v9, v9, v163, v164
  v_max3_f32 v9, v9, v165, v166
  v_max3_f32 v9, v9, v167, v168
  v_max3_f32 v9, v9, v169, v170
  v_max3_f32 v9, v9, v171, v172
  v_max3_f32 v9, v9, v173, v174
  v_max_f32 v9, v9, v175
  s_waitcnt lgkmcnt(14)
  v_mfma_f32_32x32x16_bf16 v[96:111], v[48:51], v[176:179], v[96:111]
  v_mov_b32 v10, v9
  s_waitcnt lgkmcnt(12)
  v_mfma_f32_32x32x16_bf16 v[112:127], v[52:55], v[176:179], v[112:127]
  s_waitcnt lgkmcnt(10)
  v_mfma_f32_32x32x16_bf16 v[128:143], v[56:59], v[176:179], v[128:143]
  v_permlane32_swap_b32 v9, v10
  s_waitcnt lgkmcnt(8)
  v_mfma_f32_32x32x16_bf16 v[144:159], v[60:63], v[176:179], v[144:159]
  s_waitcnt lgkmcnt(6)
  v_mfma_f32_32x32x16_bf16 v[96:111], v[64:67], v[180:183], v[96:111]
  v_max_f32 v9, v9, v10
  s_waitcnt lgkmcnt(4)
  v_mfma_f32_32x32x16_bf16 v[112:127], v[68:71], v[180:183], v[112:127]
  s_waitcnt lgkmcnt(2)
  v_mfma_f32_32x32x16_bf16 v[128:143], v[72:75], v[180:183], v[128:143]
  v_mul_f32 v9, s68, v9
  s_waitcnt lgkmcnt(0)
  v_mfma_f32_32x32x16_bf16 v[144:159], v[76:79], v[180:183], v[144:159]
  s_cmp_lt_u32 s3, 4
  s_cbranch_scc1 L_g1925
  s_add_u32 m0, s14, 98304
  s_nop 0
  buffer_load_dwordx4 v14, s[56:59], s13 offen offset:0 nt lds
  buffer_load_dwordx4 v14, s[56:59], s13 offen offset:1024 nt lds
  buffer_load_dwordx4 v14, s[56:59], s13 offen offset:2048 nt lds
  buffer_load_dwordx4 v14, s[56:59], s13 offen offset:3072 nt lds
  s_add_u32 s13, s13, 8192
  s_and_b32 s13, s13, 0x1ffff
L_g1925:
  v_add_f32 v10, v9, v7
  v_cmp_lt_f32 vcc, 0x41000000, v10
  s_nop 7
  s_cbranch_vccz L_fast_1938
  s_call_b64 s[80:81], L_slow
L_fast_1938:
  s_waitcnt vmcnt(8)
  s_barrier
  s_cmp_lt_u32 s3, 4
  s_cbranch_scc0 L_g1942
  s_lshl_b32 s69, s10, 15
  s_add_u32 s69, s69, s77
  s_add_u32 m0, s75, 0
  s_add_u32 s10, s10, 1
  s_and_b32 s10, s10, 15
  buffer_load_dwordx4 v18, s[60:63], s69 offen offset:0 lds
  buffer_load_dwordx4 v19, s[60:63], s69 offen offset:1024 lds
  buffer_load_dwordx4 v20, s[60:63], s69 offen offset:2048 lds
  buffer_load_dwordx4 v21, s[60:63], s69 offen offset:3072 lds
L_g1942:
  v_xor_b32 v34, 0x10000, v34
  ds_read_b128 v[48:51], v34 offset:32768
  v_xor_b32 v35, 0x10000, v35
  ds_read_b128 v[52:55], v35 offset:32768
  v_xor_b32 v36, 0x10000, v36
  ds_read_b128 v[56:59], v36 offset:32768
  v_xor_b32 v37, 0x10000, v37
  ds_read_b128 v[60:63], v37 offset:32768
  v_xor_b32 v38, 0x10000, v38
  ds_read_b128 v[64:67], v38 offset:32768
  v_xor_b32 v39, 0x10000, v39
  ds_read_b128 v[68:71], v39 offset:32768
  v_xor_b32 v40, 0x10000, v40
  ds_read_b128 v[72:75], v40 offset:32768
  v_xor_b32 v41, 0x10000, v41
  ds_read_b128 v[76:79], v41 offset:32768
  v_fma_f32 v160, v160, s68, v7
  v_fma_f32 v161, v161, s68, v7
  v_fma_f32 v162, v162, s68, v7
  v_fma_f32 v163, v163, s68, v7
  v_exp_f32 v160, v160
  v_exp_f32 v161, v161
  v_exp_f32 v162, v162
  v_exp_f32 v163, v163
  v_add_f32 v8, v8, v160
  v_add_f32 v8, v8, v161
  v_add_f32 v8, v8, v162
  v_add_f32 v8, v8, v163
  v_cvt_pk_bf16_f32 v160, v160, v161
  v_cvt_pk_bf16_f32 v161, v162, v163
  s_waitcnt lgkmcnt(7)
  v_mfma_f32_32x32x16_bf16 v[176:191], v[48:51], v[192:195], 0
  v_fma_f32 v164, v164, s68, v7
  v_fma_f32 v165, v165, s68, v7
  v_fma_f32 v166, v166, s68, v7
  v_fma_f32 v167, v167, s68, v7
  v_exp_f32 v164, v164
  s_waitcnt lgkmcnt(6)
  v_mfma_f32_32x32x16_bf16 v[176:191], v[52:55], v[196:199], v[176:191]
  v_exp_f32 v165, v165
  v_exp_f32 v166, v166
  v_exp_f32 v167, v167
  v_add_f32 v8, v8, v164
  v_add_f32 v8, v8, v165
  s_waitcnt lgkmcnt(5)
  v_mfma_f32_32x32x16_bf16 v[176:191], v[56:59], v[200:203], v[176:191]
  v_add_f32 v8, v8, v166
  v_add_f32 v8, v8, v167
  v_cvt_pk_bf16_f32 v162, v164, v165
  v_cvt_pk_bf16_f32 v163, v166, v167
  v_fma_f32 v168, v168, s68, v7
  v_fma_f32 v169, v169, s68, v7
  s_waitcnt lgkmcnt(4)
  v_mfma_f32_32x32x16_bf16 v[176:191], v[60:63], v[204:207], v[176:191]
  v_fma_f32 v170, v170, s68, v7
  v_fma_f32 v171, v171, s68, v7
  v_exp_f32 v168, v168
  v_exp_f32 v169, v169
  v_exp_f32 v170, v170
  s_waitcnt lgkmcnt(3)
  v_mfma_f32_32x32x16_bf16 v[176:191], v[64:67], v[208:211], v[176:191]
  v_exp_f32 v171, v171
  v_add_f32 v8, v8, v168
  v_add_f32 v8, v8, v169
  v_add_f32 v8, v8, v170
  v_add_f32 v8, v8, v171
  s_waitcnt lgkmcnt(2)
  v_mfma_f32_32x32x16_bf16 v[176:191], v[68:71], v[212:215], v[176:191]
  v_cvt_pk_bf16_f32 v164, v168, v169
  v_cvt_pk_bf16_f32 v165, v170, v171
  v_fma_f32 v172, v172, s68, v7
  v_fma_f32 v173, v173, s68, v7
  v_fma_f32 v174, v174, s68, v7
  v_fma_f32 v175, v175, s68, v7
  s_waitcnt lgkmcnt(1)
  v_mfma_f32_32x32x16_bf16 v[176:191], v[72:75], v[216:219], v[176:191]
  v_exp_f32 v172, v172
  v_exp_f32 v173, v173
  v_exp_f32 v174, v174
  v_exp_f32 v175, v175
  s_waitcnt lgkmcnt(0)
  v_mfma_f32_32x32x16_bf16 v[176:191], v[76:79], v[220:223], v[176:191]
  v_add_f32 v8, v8, v172
  v_add_f32 v8, v8, v173
  v_add_f32 v8, v8, v174
  v_add_f32 v8, v8, v175
  v_cvt_pk_bf16_f32 v166, v172, v173
  v_cvt_pk_bf16_f32 v167, v174, v175
  s_cmp_lt_u32 s3, 4
  s_cbranch_scc1 L_g2041
  s_lshl_b32 s69, s10, 15
  s_add_u32 s69, s69, s77
  s_add_u32 m0, s75, 0
  s_add_u32 s10, s10, 1
  s_and_b32 s10, s10, 15
  buffer_load_dwordx4 v18, s[60:63], s69 offen offset:0 lds
  buffer_load_dwordx4 v19, s[60:63], s69 offen offset:1024 lds
  buffer_load_dwordx4 v20, s[60:63], s69 offen offset:2048 lds
  buffer_load_dwordx4 v21, s[60:63], s69 offen offset:3072 lds
L_g2041:
  s_waitcnt vmcnt(8)
  s_barrier
  s_cmp_lt_u32 s3, 4
  s_cbranch_scc0 L_g2054
  s_lshl_b32 s69, s10, 15
  s_add_u32 s69, s69, s77
  s_add_u32 m0, s75, 32768
  s_add_u32 s10, s10, 1
  s_and_b32 s10, s10, 15
  buffer_load_dwordx4 v18, s[60:63], s69 offen offset:0 lds
  buffer_load_dwordx4 v19, s[60:63], s69 offen offset:1024 lds
  buffer_load_dwordx4 v20, s[60:63], s69 offen offset:2048 lds
  buffer_load_dwordx4 v21, s[60:63], s69 offen offset:3072 lds
L_g2054:
  v_xor_b32 v30, 0x10000, v30
  v_xor_b32 v31, 0x10000, v31
  v_xor_b32 v32, 0x10000, v32
  v_xor_b32 v33, 0x10000, v33
  ds_read_b64_tr_b16 v[48:49], v30 offset:0
  ds_read_b64_tr_b16 v[50:51], v30 offset:2048
  ds_read_b64_tr_b16 v[52:53], v31 offset:0
  ds_read_b64_tr_b16 v[54:55], v31 offset:2048
  ds_read_b64_tr_b16 v[56:57], v32 offset:0
  ds_read_b64_tr_b16 v[58:59], v32 offset:2048
  ds_read_b64_tr_b16 v[60:61], v33 offset:0
  ds_read_b64_tr_b16 v[62:63], v33 offset:2048
  ds_read_b64_tr_b16 v[64:65], v30 offset:4096
  ds_read_b64_tr_b16 v[66:67], v30 offset:6144
  ds_read_b64_tr_b16 v[68:69], v31 offset:4096
  ds_read_b64_tr_b16 v[70:71], v31 offset:6144
  ds_read_b64_tr_b16 v[72:73], v32 offset:4096
  ds_read_b64_tr_b16 v[74:75], v32 offset:6144
  ds_read_b64_tr_b16 v[76:77], v33 offset:4096
  ds_read_b64_tr_b16 v[78:79], v33 offset:6144
  v_max3_f32 v9, v176, v177, v178
  v_max3_f32 v9, v9, v179, v180
  v_max3_f32 v9, v9, v181, v182
  v_max3_f32 v9, v9, v183, v184
  v_max3_f32 v9, v9, v185, v186
  v_max3_f32 v9, v9, v187, v188
  v_max3_f32 v9, v9, v189, v190
  v_max_f32 v9, v9, v191
  s_waitcnt lgkmcnt(14)
  v_mfma_f32_32x32x16_bf16 v[96:111], v[48:51], v[160:163], v[96:111]
  v_mov_b32 v10, v9
  s_waitcnt lgkmcnt(12)
  v_mfma_f32_32x32x16_bf16 v[112:127], v[52:55], v[160:163], v[112:127]
  s_waitcnt lgkmcnt(10)
  v_mfma_f32_32x32x16_bf16 v[128:143], v[56:59], v[160:163], v[128:143]
  v_permlane32_swap_b32 v9, v10
  s_waitcnt lgkmcnt(8)
  v_mfma_f32_32x32x16_bf16 v[144:159], v[60:63], v[160:163], v[144:159]
  s_waitcnt lgkmcnt(6)
  v_mfma_f32_32x32x16_bf16 v[96:111], v[64:67], v[164:167], v[96:111]
  v_max_f32 v9, v9, v10
  s_waitcnt lgkmcnt(4)
  v_mfma_f32_32x32x16_bf16 v[112:127], v[68:71], v[164:167], v[112:127]
  s_waitcnt lgkmcnt(2)
  v_mfma_f32_32x32x16_bf16 v[128:143], v[72:75], v[164:167], v[128:143]
  v_mul_f32 v9, s68, v9
  s_waitcnt lgkmcnt(0)
  v_mfma_f32_32x32x16_bf16 v[144:159], v[76:79], v[164:167], v[144:159]
  s_cmp_lt_u32 s3, 4
  s_cbranch_scc1 L_g2113
  s_lshl_b32 s69, s10, 15
  s_add_u32 s69, s69, s77
  s_add_u32 m0, s75, 32768
  s_add_u32 s10, s10, 1
  s_and_b32 s10, s10, 15
  buffer_load_dwordx4 v18, s[60:63], s69 offen offset:0 lds
  buffer_load_dwordx4 v19, s[60:63], s69 offen offset:1024 lds
  buffer_load_dwordx4 v20, s[60:63], s69 offen offset:2048 lds
  buffer_load_dwordx4 v21, s[60:63], s69 offen offset:3072 lds
L_g2113:
  v_add_f32 v10, v9, v7
  v_cmp_lt_f32 vcc, 0x41000000, v10
  s_nop 7
  s_cbranch_vccz L_fast_2127
  s_call_b64 s[80:81], L_slow
L_fast_2127:
  v_fma_f32 v176, v176, s68, v7
  v_fma_f32 v177, v177, s68, v7
  v_fma_f32 v178, v178, s68, v7
  v_fma_f32 v179, v179, s68, v7
  v_exp_f32 v176, v176
  v_exp_f32 v177, v177
  v_exp_f32 v178, v178
  v_exp_f32 v179, v179
  v_add_f32 v8, v8, v176
  v_add_f32 v8, v8, v177
  v_add_f32 v8, v8, v178
  v_add_f32 v8, v8, v179
  v_cvt_pk_bf16_f32 v176, v176, v177
  v_cvt_pk_bf16_f32 v177, v178, v179
  v_fma_f32 v180, v180, s68, v7
  v_fma_f32 v181, v181, s68, v7
  v_fma_f32 v182, v182, s68, v7
  v_fma_f32 v183, v183, s68, v7
  v_exp_f32 v180, v180
  v_exp_f32 v181, v181
  v_exp_f32 v182, v182
  v_exp_f32 v183, v183
  v_add_f32 v8, v8, v180
  v_add_f32 v8, v8, v181
  v_add_f32 v8, v8, v182
  v_add_f32 v8, v8, v183
  v_cvt_pk_bf16_f32 v178, v180, v181
  v_cvt_pk_bf16_f32 v179, v182, v183
  v_fma_f32 v184, v184, s68, v7
  v_fma_f32 v185, v185, s68, v7
  v_fma_f32 v186, v186, s68, v7
  v_fma_f32 v187, v187, s68, v7
  v_exp_f32 v184, v184
  v_exp_f32 v185, v185
  v_exp_f32 v186, v186
  v_exp_f32 v187, v187
  v_add_f32 v8, v8, v184
  v_add_f32 v8, v8, v185
  v_add_f32 v8, v8, v186
  v_add_f32 v8, v8, v187
  v_cvt_pk_bf16_f32 v180, v184, v185
  v_cvt_pk_bf16_f32 v181, v186, v187
  v_fma_f32 v188, v188, s68, v7
  v_fma_f32 v189, v189, s68, v7
  v_fma_f32 v190, v190, s68, v7
  v_fma_f32 v191, v191, s68, v7
  v_exp_f32 v188, v188
  v_exp_f32 v189, v189
  v_exp_f32 v190, v190
  v_exp_f32 v191, v191
  v_add_f32 v8, v8, v188
  v_add_f32 v8, v8, v189
  v_add_f32 v8, v8, v190
  v_add_f32 v8, v8, v191
  v_cvt_pk_bf16_f32 v182, v188, v189
  v_cvt_pk_bf16_f32 v183, v190, v191
  v_lshl_add_u32 v10, v3, 2, v5
  v_lshlrev_b32 v10, 10, v10
  v_add_u32 v10, v10, v15
  s_lshl_b32 s69, s8, 8
  v_add_u32 v10, s69, v10
  s_lshl_b32 s69, s9, 1
  s_add_u32 s70, s69, 0
  v_xor_b32 v6, s70, v5
  v_lshl_add_u32 v26, v6, 6, v10
  v_add_u32 v28, 0x10000, v26
  s_add_u32 s70, s69, 1
  v_xor_b32 v6, s70, v5
  v_lshl_add_u32 v27, v6, 6, v10
  v_add_u32 v29, 0x10000, v27
  v_mov_b32 v10, v8
  s_nop 1
  v_permlane32_swap_b32 v8, v10
  v_add_f32 v8, v8, v10
  v_rcp_f32 v11, v8
  s_lshl_b32 s69, s8, 14
  s_lshl_b32 s70, s9, 10
  s_add_u32 s69, s69, s70
  s_add_u32 s69, s69, 98304
  v_add_u32 v13, s69, v2
  s_waitcnt vmcnt(8)
  s_barrier
  s_cmp_lt_u32 s3, 4
  s_cbranch_scc0 L_g2211
  s_lshl_b32 s69, s10, 15
  s_add_u32 s69, s69, s77
  s_add_u32 m0, s75, 65536
  s_add_u32 s10, s10, 1
  s_and_b32 s10, s10, 15
  buffer_load_dwordx4 v18, s[60:63], s69 offen offset:0 lds
  buffer_load_dwordx4 v19, s[60:63], s69 offen offset:1024 lds
  buffer_load_dwordx4 v20, s[60:63], s69 offen offset:2048 lds
  buffer_load_dwordx4 v21, s[60:63], s69 offen offset:3072 lds
L_g2211:
  ds_read_b64_tr_b16 v[48:49], v30 offset:32768
  ds_read_b64_tr_b16 v[50:51], v30 offset:34816
  ds_read_b64_tr_b16 v[52:53], v31 offset:32768
  ds_read_b64_tr_b16 v[54:55], v31 offset:34816
  ds_read_b64_tr_b16 v[56:57], v32 offset:32768
  ds_read_b64_tr_b16 v[58:59], v32 offset:34816
  ds_read_b64_tr_b16 v[60:61], v33 offset:32768
  ds_read_b64_tr_b16 v[62:63], v33 offset:34816
  ds_read_b64_tr_b16 v[64:65], v30 offset:36864
  ds_read_b64_tr_b16 v[66:67], v30 offset:38912
  ds_read_b64_tr_b16 v[68:69], v31 offset:36864
  ds_read_b64_tr_b16 v[70:71], v31 offset:38912
  ds_read_b64_tr_b16 v[72:73], v32 offset:36864
  ds_read_b64_tr_b16 v[74:75], v32 offset:38912
  ds_read_b64_tr_b16 v[76:77], v33 offset:36864
  ds_read_b64_tr_b16 v[78:79], v33 offset:38912
  s_waitcnt lgkmcnt(14)
  v_mfma_f32_32x32x16_bf16 v[96:111], v[48:51], v[176:179], v[96:111]
  s_waitcnt lgkmcnt(12)
  v_mfma_f32_32x32x16_bf16 v[112:127], v[52:55], v[176:179], v[112:127]
  s_waitcnt lgkmcnt(10)
  v_mfma_f32_32x32x16_bf16 v[128:143], v[56:59], v[176:179], v[128:143]
  s_waitcnt lgkmcnt(8)
  v_mfma_f32_32x32x16_bf16 v[144:159], v[60:63], v[176:179], v[144:159]
  s_waitcnt lgkmcnt(6)
  v_mfma_f32_32x32x16_bf16 v[96:111], v[64:67], v[180:183], v[96:111]
  s_waitcnt lgkmcnt(4)
  v_mfma_f32_32x32x16_bf16 v[112:127], v[68:71], v[180:183], v[112:127]
  s_waitcnt lgkmcnt(2)
  v_mfma_f32_32x32x16_bf16 v[128:143], v[72:75], v[180:183], v[128:143]
  s_waitcnt lgkmcnt(0)
  v_mfma_f32_32x32x16_bf16 v[144:159], v[76:79], v[180:183], v[144:159]
  s_cmp_lt_u32 s3, 4
  s_cbranch_scc1 L_g2254
  s_lshl_b32 s69, s10, 15
  s_add_u32 s69, s69, s77
  s_add_u32 m0, s75, 65536
  s_add_u32 s10, s10, 1
  s_and_b32 s10, s10, 15
  buffer_load_dwordx4 v18, s[60:63], s69 offen offset:0 lds
  buffer_load_dwordx4 v19, s[60:63], s69 offen offset:1024 lds
  buffer_load_dwordx4 v20, s[60:63], s69 offen offset:2048 lds
  buffer_load_dwordx4 v21, s[60:63], s69 offen offset:3072 lds
L_g2254:
  s_nop 9
  s_branch L_join
L_A:
  s_waitcnt vmcnt(9)
  s_waitcnt lgkmcnt(0)
  s_barrier
  ds_read_b128 v[80:83], v44 offset:0
  ds_read_b64_tr_b16 v[48:49], v26 offset:32768
  ds_read_b64_tr_b16 v[50:51], v26 offset:36864
  ds_read_b64_tr_b16 v[52:53], v27 offset:32768
  ds_read_b64_tr_b16 v[54:55], v27 offset:36864
  ds_read_b64_tr_b16 v[56:57], v28 offset:32768
  ds_read_b64_tr_b16 v[58:59], v28 offset:36864
  ds_read_b64_tr_b16 v[60:61], v29 offset:32768
  ds_read_b64_tr_b16 v[62:63], v29 offset:36864
  v_mfma_f32_32x32x16_bf16 v[96:111], v[64:67], v[84:87], v[96:111]
  v_mfma_f32_32x32x16_bf16 v[112:127], v[68:71], v[84:87], v[112:127]
  v_mfma_f32_32x32x16_bf16 v[128:143], v[72:75], v[84:87], v[128:143]
  v_mfma_f32_32x32x16_bf16 v[144:159], v[76:79], v[84:87], v[144:159]
  ds_read_b128 v[84:87], v45 offset:0
  ds_read_b64_tr_b16 v[64:65], v26 offset:49152
  ds_read_b64_tr_b16 v[66:67], v26 offset:53248
  ds_read_b64_tr_b16 v[68:69], v27 offset:49152
  ds_read_b64_tr_b16 v[70:71], v27 offset:53248
  ds_read_b64_tr_b16 v[72:73], v28 offset:49152
  ds_read_b64_tr_b16 v[74:75], v28 offset:53248
  ds_read_b64_tr_b16 v[76:77], v29 offset:49152
  ds_read_b64_tr_b16 v[78:79], v29 offset:53248
  s_waitcnt lgkmcnt(15)
  v_mfma_f32_32x32x16_bf16 v[96:111], v[48:51], v[80:83], v[96:111]
  s_waitcnt lgkmcnt(13)
  v_mfma_f32_32x32x16_bf16 v[112:127], v[52:55], v[80:83], v[112:127]
  s_add_u32 m0, s14, 0
  s_nop 0
  buffer_load_dwordx4 v22, s[52:55], s12 offen offset:0 nt lds
  s_add_u32 s12, s12, 8192
  s_and_b32 s12, s12, 0x1ffff
  s_waitcnt lgkmcnt(11)
  v_mfma_f32_32x32x16_bf16 v[128:143], v[56:59], v[80:83], v[128:143]
  s_waitcnt lgkmcnt(9)
  v_mfma_f32_32x32x16_bf16 v[144:159], v[60:63], v[80:83], v[144:159]
  s_waitcnt vmcnt(5)
  s_waitcnt lgkmcnt(0)
  s_barrier
  v_xor_b32 v26, 0x10000, v26
  v_xor_b32 v27, 0x10000, v27
  v_xor_b32 v28, 0x10000, v28
  v_xor_b32 v29, 0x10000, v29
  ds_read_b128 v[80:83], v42 offset:8192
  ds_read_b64_tr_b16 v[48:49], v26 offset:0
  ds_read_b64_tr_b16 v[50:51], v26 offset:4096
  ds_read_b64_tr_b16 v[52:53], v27 offset:0
  ds_read_b64_tr_b16 v[54:55], v27 offset:4096
  ds_read_b64_tr_b16 v[56:57], v28 offset:0
  ds_read_b64_tr_b16 v[58:59], v28 offset:4096
  ds_read_b64_tr_b16 v[60:61], v29 offset:0
  ds_read_b64_tr_b16 v[62:63], v29 offset:4096
  v_mfma_f32_32x32x16_bf16 v[96:111], v[64:67], v[84:87], v[96:111]
  v_mfma_f32_32x32x16_bf16 v[112:127], v[68:71], v[84:87], v[112:127]
  v_mfma_f32_32x32x16_bf16 v[128:143], v[72:75], v[84:87], v[128:143]
  v_mfma_f32_32x32x16_bf16 v[144:159], v[76:79], v[84:87], v[144:159]
  ds_read_b128 v[84:87], v43 offset:8192
  ds_read_b64_tr_b16 v[64:65], v26 offset:16384
  ds_read_b64_tr_b16 v[66:67], v26 offset:20480
  ds_read_b64_tr_b16 v[68:69], v27 offset:16384
  ds_read_b64_tr_b16 v[70:71], v27 offset:20480
  ds_read_b64_tr_b16 v[72:73], v28 offset:16384
  ds_read_b64_tr_b16 v[74:75], v28 offset:20480
  ds_read_b64_tr_b16 v[76:77], v29 offset:16384
  ds_read_b64_tr_b16 v[78:79], v29 offset:20480
  s_waitcnt lgkmcnt(15)
  v_mfma_f32_32x32x16_bf16 v[96:111], v[48:51], v[80:83], v[96:111]
  s_waitcnt lgkmcnt(13)
  v_mfma_f32_32x32x16_bf16 v[112:127], v[52:55], v[80:83], v[112:127]
  s_add_u32 m0, s14, 32768
  s_nop 0
  buffer_load_dwordx4 v22, s[52:55], s12 offen offset:0 nt lds
  s_add_u32 s12, s12, 8192
  s_and_b32 s12, s12, 0x1ffff
  s_waitcnt lgkmcnt(11)
  v_mfma_f32_32x32x16_bf16 v[128:143], v[56:59], v[80:83], v[128:143]
  s_waitcnt lgkmcnt(9)
  v_mfma_f32_32x32x16_bf16 v[144:159], v[60:63], v[80:83], v[144:159]
  s_waitcnt vmcnt(2)
  s_waitcnt lgkmcnt(0)
  s_barrier
  ds_read_b128 v[80:83], v44 offset:8192
  ds_read_b64_tr_b16 v[48:49], v26 offset:32768
  ds_read_b64_tr_b16 v[50:51], v26 offset:36864
  ds_read_b64_tr_b16 v[52:53], v27 offset:32768
  ds_read_b64_tr_b16 v[54:55], v27 offset:36864
  ds_read_b64_tr_b16 v[56:57], v28 offset:32768
  ds_read_b64_tr_b16 v[58:59], v28 offset:36864
  ds_read_b64_tr_b16 v[60:61], v29 offset:32768
  ds_read_b64_tr_b16 v[62:63], v29 offset:36864
  v_mfma_f32_32x32x16_bf16 v[96:111], v[64:67], v[84:87], v[96:111]
  v_mfma_f32_32x32x16_bf16 v[112:127], v[68:71], v[84:87], v[112:127]
  v_mfma_f32_32x32x16_bf16 v[128:143], v[72:75], v[84:87], v[128:143]
  v_mfma_f32_32x32x16_bf16 v[144:159], v[76:79], v[84:87], v[144:159]
  ds_read_b128 v[84:87], v45 offset:8192
  ds_read_b64_tr_b16 v[64:65], v26 offset:49152
  ds_read_b64_tr_b16 v[66:67], v26 offset:53248
  ds_read_b64_tr_b16 v[68:69], v27 offset:49152
  ds_read_b64_tr_b16 v[70:71], v27 offset:53248
  ds_read_b64_tr_b16 v[72:73], v28 offset:49152
  ds_read_b64_tr_b16 v[74:75], v28 offset:53248
  ds_read_b64_tr_b16 v[76:77], v29 offset:49152
  ds_read_b64_tr_b16 v[78:79], v29 offset:53248
  s_waitcnt lgkmcnt(15)
  v_mfma_f32_32x32x16_bf16 v[96:111], v[48:51], v[80:83], v[96:111]
  s_waitcnt lgkmcnt(13)
  v_mfma_f32_32x32x16_bf16 v[112:127], v[52:55], v[80:83], v[112:127]
  s_add_u32 m0, s14, 65536
  s_nop 0
  buffer_load_dwordx4 v14, s[56:59], s13 offen offset:0 nt lds
  s_add_u32 s13, s13, 8192
  s_and_b32 s13, s13, 0x1ffff
  s_waitcnt lgkmcnt(11)
  v_mfma_f32_32x32x16_bf16 v[128:143], v[56:59], v[80:83], v[128:143]
  s_waitcnt lgkmcnt(9)
  v_mfma_f32_32x32x16_bf16 v[144:159], v[60:63], v[80:83], v[144:159]
  s_waitcnt lgkmcnt(6)
  v_mfma_f32_32x32x16_bf16 v[96:111], v[64:67], v[84:87], v[96:111]
  s_waitcnt lgkmcnt(4)
  v_mfma_f32_32x32x16_bf16 v[112:127], v[68:71], v[84:87], v[112:127]
  s_waitcnt lgkmcnt(2)
  v_mfma_f32_32x32x16_bf16 v[128:143], v[72:75], v[84:87], v[128:143]
  s_waitcnt lgkmcnt(0)
  v_mfma_f32_32x32x16_bf16 v[144:159], v[76:79], v[84:87], v[144:159]
  s_nop 5
  v_cvt_pk_bf16_f32 v192, v96, v97
  v_cvt_pk_bf16_f32 v193, v98, v99
  v_cvt_pk_bf16_f32 v194, v100, v101
  v_cvt_pk_bf16_f32 v195, v102, v103
  v_cvt_pk_bf16_f32 v196, v104, v105
  v_cvt_pk_bf16_f32 v197, v106, v107
  v_cvt_pk_bf16_f32 v198, v108, v109
  v_cvt_pk_bf16_f32 v199, v110, v111
  v_cvt_pk_bf16_f32 v200, v112, v113
  v_cvt_pk_bf16_f32 v201, v114, v115
  v_cvt_pk_bf16_f32 v202, v116, v117
  v_cvt_pk_bf16_f32 v203, v118, v119
  v_cvt_pk_bf16_f32 v204, v120, v121
  v_cvt_pk_bf16_f32 v205, v122, v123
  v_cvt_pk_bf16_f32 v206, v124, v125
  v_cvt_pk_bf16_f32 v207, v126, v127
  v_cvt_pk_bf16_f32 v208, v128, v129
  v_cvt_pk_bf16_f32 v209, v130, v131
  v_cvt_pk_bf16_f32 v210, v132, v133
  v_cvt_pk_bf16_f32 v211, v134, v135
  v_cvt_pk_bf16_f32 v212, v136, v137
  v_cvt_pk_bf16_f32 v213, v138, v139
  v_cvt_pk_bf16_f32 v214, v140, v141
  v_cvt_pk_bf16_f32 v215, v142, v143
  v_cvt_pk_bf16_f32 v216, v144, v145
  v_cvt_pk_bf16_f32 v217, v146, v147
  v_cvt_pk_bf16_f32 v218, v148, v149
  v_cvt_pk_bf16_f32 v219, v150, v151
  v_cvt_pk_bf16_f32 v220, v152, v153
  v_cvt_pk_bf16_f32 v221, v154, v155
  v_cvt_pk_bf16_f32 v222, v156, v157
  v_cvt_pk_bf16_f32 v223, v158, v159
  v_mov_b32 v8, 0
  s_waitcnt vmcnt(2)
  s_barrier
  ds_read_b128 v[48:51], v34 offset:0
  ds_read_b128 v[52:55], v35 offset:0
  ds_read_b128 v[56:59], v36 offset:0
  ds_read_b128 v[60:63], v37 offset:0
  ds_read_b128 v[64:67], v38 offset:0
  ds_read_b128 v[68:71], v39 offset:0
  ds_read_b128 v[72:75], v40 offset:0
  ds_read_b128 v[76:79], v41 offset:0
  s_add_u32 m0, s14, 98304
  s_nop 0
  buffer_load_dwordx4 v22, s[52:55], s12 offen offset:0 nt lds
  s_add_u32 s12, s12, 8192
  s_and_b32 s12, s12, 0x1ffff
  s_waitcnt lgkmcnt(7)
  v_mfma_f32_32x32x16_bf16 v[160:175], v[48:51], v[192:195], 0
  s_waitcnt lgkmcnt(6)
  v_mfma_f32_32x32x16_bf16 v[160:175], v[52:55], v[196:199], v[160:175]
  s_waitcnt lgkmcnt(5)
  v_mfma_f32_32x32x16_bf16 v[160:175], v[56:59], v[200:203], v[160:175]
  s_waitcnt lgkmcnt(4)
  v_mfma_f32_32x32x16_bf16 v[160:175], v[60:63], v[204:207], v[160:175]
  s_waitcnt lgkmcnt(3)
  v_mfma_f32_32x32x16_bf16 v[160:175], v[64:67], v[208:211], v[160:175]
  s_waitcnt lgkmcnt(2)
  v_mfma_f32_32x32x16_bf16 v[160:175], v[68:71], v[212:215], v[160:175]
  s_waitcnt lgkmcnt(1)
  v_mfma_f32_32x32x16_bf16 v[160:175], v[72:75], v[216:219], v[160:175]
  s_waitcnt lgkmcnt(0)
  v_mfma_f32_32x32x16_bf16 v[160:175], v[76:79], v[220:223], v[160:175]
  s_nop 11
  v_max3_f32 v9, v160, v161, v162
  v_max3_f32 v9, v9, v163, v164
  v_max3_f32 v9, v9, v165, v166
  v_max3_f32 v9, v9, v167, v168
  v_max3_f32 v9, v9, v169, v170
  v_max3_f32 v9, v9, v171, v172
  v_max3_f32 v9, v9, v173, v174
  v_max_f32 v9, v9, v175
  v_mov_b32 v10, v9
  s_nop 1
  v_permlane32_swap_b32 v9, v10
  v_max_f32 v9, v9, v10
  v_mul_f32 v9, s68, v9
  v_sub_f32 v7, 0, v9
  s_waitcnt vmcnt(2)
  s_barrier
  ds_read_b128 v[48:51], v34 offset:32768
  ds_read_b128 v[52:55], v35 offset:32768
  ds_read_b128 v[56:59], v36 offset:32768
  ds_read_b128 v[60:63], v37 offset:32768
  ds_read_b128 v[64:67], v38 offset:32768
  ds_read_b128 v[68:71], v39 offset:32768
  ds_read_b128 v[72:75], v40 offset:32768
  ds_read_b128 v[76:79], v41 offset:32768
  s_add_u32 m0, s14, 0
  s_nop 0
  buffer_load_dwordx4 v14, s[56:59], s13 offen offset:0 nt lds
  s_add_u32 s13, s13, 8192
  s_and_b32 s13, s13, 0x1ffff
  v_fma_f32 v160, v160, s68, v7
  v_fma_f32 v161, v161, s68, v7
  v_fma_f32 v162, v162, s68, v7
  v_fma_f32 v163, v163, s68, v7
  v_exp_f32 v160, v160
  v_exp_f32 v161, v161
  v_exp_f32 v162, v162
  v_exp_f32 v163, v163
  v_add_f32 v8, v8, v160
  v_add_f32 v8, v8, v161
  v_add_f32 v8, v8, v162
  v_add_f32 v8, v8, v163
  v_cvt_pk_bf16_f32 v160, v160, v161
  v_cvt_pk_bf16_f32 v161, v162, v163
  s_waitcnt lgkmcnt(7)
  v_mfma_f32_32x32x16_bf16 v[176:191], v[48:51], v[192:195], 0
  v_fma_f32 v164, v164, s68, v7
  v_fma_f32 v165, v165, s68, v7
  v_fma_f32 v166, v166, s68, v7
  v_fma_f32 v167, v167, s68, v7
  v_exp_f32 v164, v164
  s_waitcnt lgkmcnt(6)
  v_mfma_f32_32x32x16_bf16 v[176:191], v[52:55], v[196:199], v[176:191]
  v_exp_f32 v165, v165
  v_exp_f32 v166, v166
  v_exp_f32 v167, v167
  v_add_f32 v8, v8, v164
  v_add_f32 v8, v8, v165
  s_waitcnt lgkmcnt(5)
  v_mfma_f32_32x32x16_bf16 v[176:191], v[56:59], v[200:203], v[176:191]
  v_add_f32 v8, v8, v166
  v_add_f32 v8, v8, v167
  v_cvt_pk_bf16_f32 v162, v164, v165
  v_cvt_pk_bf16_f32 v163, v166, v167
  v_fma_f32 v168, v168, s68, v7
  v_fma_f32 v169, v169, s68, v7
  s_waitcnt lgkmcnt(4)
  v_mfma_f32_32x32x16_bf16 v[176:191], v[60:63], v[204:207], v[176:191]
  v_fma_f32 v170, v170, s68, v7
  v_fma_f32 v171, v171, s68, v7
  v_exp_f32 v168, v168
  v_exp_f32 v169, v169
  v_exp_f32 v170, v170
  s_waitcnt lgkmcnt(3)
  v_mfma_f32_32x32x16_bf16 v[176:191], v[64:67], v[208:211], v[176:191]
  v_exp_f32 v171, v171
  v_add_f32 v8, v8, v168
  v_add_f32 v8, v8, v169
  v_add_f32 v8, v8, v170
  v_add_f32 v8, v8, v171
  s_waitcnt lgkmcnt(2)
  v_mfma_f32_32x32x16_bf16 v[176:191], v[68:71], v[212:215], v[176:191]
  v_cvt_pk_bf16_f32 v164, v168, v169
  v_cvt_pk_bf16_f32 v165, v170, v171
  v_fma_f32 v172, v172, s68, v7
  v_fma_f32 v173, v173, s68, v7
  v_fma_f32 v174, v174, s68, v7
  v_fma_f32 v175, v175, s68, v7
  s_waitcnt lgkmcnt(1)
  v_mfma_f32_32x32x16_bf16 v[176:191], v[72:75], v[216:219], v[176:191]
  v_exp_f32 v172, v172
  v_exp_f32 v173, v173
  v_exp_f32 v174, v174
  v_exp_f32 v175, v175
  s_waitcnt lgkmcnt(0)
  v_mfma_f32_32x32x16_bf16 v[176:191], v[76:79], v[220:223], v[176:191]
  v_add_f32 v8, v8, v172
  v_add_f32 v8, v8, v173
  v_add_f32 v8, v8, v174
  v_add_f32 v8, v8, v175
  v_cvt_pk_bf16_f32 v166, v172, v173
  v_cvt_pk_bf16_f32 v167, v174, v175
  s_waitcnt vmcnt(2)
  s_barrier
  v_xor_b32 v30, 0x10000, v30
  v_xor_b32 v31, 0x10000, v31
  v_xor_b32 v32, 0x10000, v32
  v_xor_b32 v33, 0x10000, v33
  ds_read_b64_tr_b16 v[48:49], v30 offset:0
  ds_read_b64_tr_b16 v[50:51], v30 offset:2048
  ds_read_b64_tr_b16 v[52:53], v31 offset:0
  ds_read_b64_tr_b16 v[54:55], v31 offset:2048
  ds_read_b64_tr_b16 v[56:57], v32 offset:0
  ds_read_b64_tr_b16 v[58:59], v32 offset:2048
  ds_read_b64_tr_b16 v[60:61], v33 offset:0
  ds_read_b64_tr_b16 v[62:63], v33 offset:2048
  ds_read_b64_tr_b16 v[64:65], v30 offset:4096
  ds_read_b64_tr_b16 v[66:67], v30 offset:6144
  ds_read_b64_tr_b16 v[68:69], v31 offset:4096
  ds_read_b64_tr_b16 v[70:71], v31 offset:6144
  ds_read_b64_tr_b16 v[72:73], v32 offset:4096
  ds_read_b64_tr_b16 v[74:75], v32 offset:6144
  ds_read_b64_tr_b16 v[76:77], v33 offset:4096
  ds_read_b64_tr_b16 v[78:79], v33 offset:6144
  s_add_u32 m0, s14, 32768
  s_nop 0
  buffer_load_dwordx4 v22, s[52:55], s12 offen offset:0 nt lds
  s_add_u32 s12, s12, 8192
  s_and_b32 s12, s12, 0x1ffff
  v_max3_f32 v9, v176, v177, v178
  v_max3_f32 v9, v9, v179, v180
  v_max3_f32 v9, v9, v181, v182
  v_max3_f32 v9, v9, v183, v184
  v_max3_f32 v9, v9, v185, v186
  v_max3_f32 v9, v9, v187, v188
  v_max3_f32 v9, v9, v189, v190
  v_max_f32 v9, v9, v191
  s_waitcnt lgkmcnt(14)
  v_mfma_f32_32x32x16_bf16 v[96:111], v[48:51], v[160:163], 0
  v_mov_b32 v10, v9
  s_waitcnt lgkmcnt(12)
  v_mfma_f32_32x32x16_bf16 v[112:127], v[52:55], v[160:163], 0
  s_waitcnt lgkmcnt(10)
  v_mfma_f32_32x32x16_bf16 v[128:143], v[56:59], v[160:163], 0
  v_permlane32_swap_b32 v9, v10
  s_waitcnt lgkmcnt(8)
  v_mfma_f32_32x32x16_bf16 v[144:159], v[60:63], v[160:163], 0
  s_waitcnt lgkmcnt(6)
  v_mfma_f32_32x32x16_bf16 v[96:111], v[64:67], v[164:167], v[96:111]
  v_max_f32 v9, v9, v10
  s_waitcnt lgkmcnt(4)
  v_mfma_f32_32x32x16_bf16 v[112:127], v[68:71], v[164:167], v[112:127]
  s_waitcnt lgkmcnt(2)
  v_mfma_f32_32x32x16_bf16 v[128:143], v[72:75], v[164:167], v[128:143]
  v_mul_f32 v9, s68, v9
  s_waitcnt lgkmcnt(0)
  v_mfma_f32_32x32x16_bf16 v[144:159], v[76:79], v[164:167], v[144:159]
  v_add_f32 v10, v9, v7
  v_cmp_lt_f32 vcc, 0x41000000, v10
  s_nop 9
  s_cbranch_vccz L_fast_2618
  s_call_b64 s[80:81], L_slow
L_fast_2618:
  s_waitcnt vmcnt(2)
  s_barrier
  v_xor_b32 v34, 0x10000, v34
  ds_read_b128 v[48:51], v34 offset:32768
  v_xor_b32 v35, 0x10000, v35
  ds_read_b128 v[52:55], v35 offset:32768
  v_xor_b32 v36, 0x10000, v36
  ds_read_b128 v[56:59], v36 offset:32768
  v_xor_b32 v37, 0x10000, v37
  ds_read_b128 v[60:63], v37 offset:32768
  v_xor_b32 v38, 0x10000, v38
  ds_read_b128 v[64:67], v38 offset:32768
  v_xor_b32 v39, 0x10000, v39
  ds_read_b128 v[68:71], v39 offset:32768
  v_xor_b32 v40, 0x10000, v40
  ds_read_b128 v[72:75], v40 offset:32768
  v_xor_b32 v41, 0x10000, v41
  ds_read_b128 v[76:79], v41 offset:32768
  s_add_u32 m0, s14, 65536
  s_nop 0
  buffer_load_dwordx4 v14, s[56:59], s13 offen offset:0 nt lds
  s_add_u32 s13, s13, 8192
  s_and_b32 s13, s13, 0x1ffff
  v_fma_f32 v176, v176, s68, v7
  v_fma_f32 v177, v177, s68, v7
  v_fma_f32 v178, v178, s68, v7
  v_fma_f32 v179, v179, s68, v7
  v_exp_f32 v176, v176
  v_exp_f32 v177, v177
  v_exp_f32 v178, v178
  v_exp_f32 v179, v179
  v_add_f32 v8, v8, v176
  v_add_f32 v8, v8, v177
  v_add_f32 v8, v8, v178
  v_add_f32 v8, v8, v179
  v_cvt_pk_bf16_f32 v176, v176, v177
  v_cvt_pk_bf16_f32 v177, v178, v179
  s_waitcnt lgkmcnt(7)
  v_mfma_f32_32x32x16_bf16 v[160:175], v[48:51], v[192:195], 0
  v_fma_f32 v180, v180, s68, v7
  v_fma_f32 v181, v181, s68, v7
  v_fma_f32 v182, v182, s68, v7
  v_fma_f32 v183, v183, s68, v7
  v_exp_f32 v180, v180
  s_waitcnt lgkmcnt(6)
  v_mfma_f32_32x32x16_bf16 v[160:175], v[52:55], v[196:199], v[160:175]
  v_exp_f32 v181, v181
  v_exp_f32 v182, v182
  v_exp_f32 v183, v183
  v_add_f32 v8, v8, v180
  v_add_f32 v8, v8, v181
  s_waitcnt lgkmcnt(5)
  v_mfma_f32_32x32x16_bf16 v[160:175], v[56:59], v[200:203], v[160:175]
  v_add_f32 v8, v8, v182
  v_add_f32 v8, v8, v183
  v_cvt_pk_bf16_f32 v178, v180, v181
  v_cvt_pk_bf16_f32 v179, v182, v183
  v_fma_f32 v184, v184, s68, v7
  v_fma_f32 v185, v185, s68, v7
  s_waitcnt lgkmcnt(4)
  v_mfma_f32_32x32x16_bf16 v[160:175], v[60:63], v[204:207], v[160:175]
  v_fma_f32 v186, v186, s68, v7
  v_fma_f32 v187, v187, s68, v7
  v_exp_f32 v184, v184
  v_exp_f32 v185, v185
  v_exp_f32 v186, v186
  s_waitcnt lgkmcnt(3)
  v_mfma_f32_32x32x16_bf16 v[160:175], v[64:67], v[208:211], v[160:175]
  v_exp_f32 v187, v187
  v_add_f32 v8, v8, v184
  v_add_f32 v8, v8, v185
  v_add_f32 v8, v8, v186
  v_add_f32 v8, v8, v187
  s_waitcnt lgkmcnt(2)
  v_mfma_f32_32x32x16_bf16 v[160:175], v[68:71], v[212:215], v[160:175]
  v_cvt_pk_bf16_f32 v180, v184, v185
  v_cvt_pk_bf16_f32 v181, v186, v187
  v_fma_f32 v188, v188, s68, v7
  v_fma_f32 v189, v189, s68, v7
  v_fma_f32 v190, v190, s68, v7
  v_fma_f32 v191, v191, s68, v7
  s_waitcnt lgkmcnt(1)
  v_mfma_f32_32x32x16_bf16 v[160:175], v[72:75], v[216:219], v[160:175]
  v_exp_f32 v188, v188
  v_exp_f32 v189, v189
  v_exp_f32 v190, v190
  v_exp_f32 v191, v191
  s_waitcnt lgkmcnt(0)
  v_mfma_f32_32x32x16_bf16 v[160:175], v[76:79], v[220:223], v[160:175]
  v_add_f32 v8, v8, v188
  v_add_f32 v8, v8, v189
  v_add_f32 v8, v8, v190
  v_add_f32 v8, v8, v191
  v_cvt_pk_bf16_f32 v182, v188, v189
  v_cvt_pk_bf16_f32 v183, v190, v191
  s_waitcnt vmcnt(2)
  s_barrier
  v_xor_b32 v30, 0x10000, v30
  v_xor_b32 v31, 0x10000, v31
  v_xor_b32 v32, 0x10000, v32
  v_xor_b32 v33, 0x10000, v33
  ds_read_b64_tr_b16 v[48:49], v30 offset:0
  ds_read_b64_tr_b16 v[50:51], v30 offset:2048
  ds_read_b64_tr_b16 v[52:53], v31 offset:0
  ds_read_b64_tr_b16 v[54:55], v31 offset:2048
  ds_read_b64_tr_b16 v[56:57], v32 offset:0
  ds_read_b64_tr_b16 v[58:59], v32 offset:2048
  ds_read_b64_tr_b16 v[60:61], v33 offset:0
  ds_read_b64_tr_b16 v[62:63], v33 offset:2048
  ds_read_b64_tr_b16 v[64:65], v30 offset:4096
  ds_read_b64_tr_b16 v[66:67], v30 offset:6144
  ds_read_b64_tr_b16 v[68:69], v31 offset:4096
  ds_read_b64_tr_b16 v[70:71], v31 offset:6144
  ds_read_b64_tr_b16 v[72:73], v32 offset:4096
  ds_read_b64_tr_b16 v[74:75], v32 offset:6144
  ds_read_b64_tr_b16 v[76:77], v33 offset:4096
  ds_read_b64_tr_b16 v[78:79], v33 offset:6144
  s_add_u32 m0, s14, 98304
  s_nop 0
  buffer_load_dwordx4 v22, s[52:55], s12 offen offset:0 nt lds
  s_add_u32 s12, s12, 8192
  s_and_b32 s12, s12, 0x1ffff
  v_max3_f32 v9, v160, v161, v162
  v_max3_f32 v9, v9, v163, v164
  v_max3_f32 v9, v9, v165, v166
  v_max3_f32 v9, v9, v167, v168
  v_max3_f32 v9, v9, v169, v170
  v_max3_f32 v9, v9, v171, v172
  v_max3_f32 v9, v9, v173, v174
  v_max_f32 v9, v9, v175
  s_waitcnt lgkmcnt(14)
  v_mfma_f32_32x32x16_bf16 v[96:111], v[48:51], v[176:179], v[96:111]
  v_mov_b32 v10, v9
  s_waitcnt lgkmcnt(12)
  v_mfma_f32_32x32x16_bf16 v[112:127], v[52:55], v[176:179], v[112:127]
  s_waitcnt lgkmcnt(10)
  v_mfma_f32_32x32x16_bf16 v[128:143], v[56:59], v[176:179], v[128:143]
  v_permlane32_swap_b32 v9, v10
  s_waitcnt lgkmcnt(8)
  v_mfma_f32_32x32x16_bf16 v[144:159], v[60:63], v[176:179], v[144:159]
  s_waitcnt lgkmcnt(6)
  v_mfma_f32_32x32x16_bf16 v[96:111], v[64:67], v[180:183], v[96:111]
  v_max_f32 v9, v9, v10
  s_waitcnt lgkmcnt(4)
  v_mfma_f32_32x32x16_bf16 v[112:127], v[68:71], v[180:183], v[112:127]
  s_waitcnt lgkmcnt(2)
  v_mfma_f32_32x32x16_bf16 v[128:143], v[72:75], v[180:183], v[128:143]
  v_mul_f32 v9, s68, v9
  s_waitcnt lgkmcnt(0)
  v_mfma_f32_32x32x16_bf16 v[144:159], v[76:79], v[180:183], v[144:159]
  v_add_f32 v10, v9, v7
  v_cmp_lt_f32 vcc, 0x41000000, v10
  s_nop 9
  s_cbranch_vccz L_fast_2773
  s_call_b64 s[80:81], L_slow
L_fast_2773:
  s_cmp_lg_u32 s3, 0
  s_cbranch_scc1 L_nonA
  s_waitcnt lgkmcnt(0)
  s_memrealtime s[100:101]
  s_waitcnt lgkmcnt(0)
  s_or_b32 s42, s100, 1
  s_mov_b64 exec, 1
  v_mov_b32 v16, s42
  v_mov_b32 v17, 0
  buffer_atomic_cmpswap v[16:17], v17, s[84:87], 0 offen offset:128 sc0 sc1
  s_mov_b64 exec, -1
  s_nop 1
L_nonA:
  s_mov_b32 s11, 5
  s_nop 1
L_attA:
  s_waitcnt vmcnt(2)
  s_barrier
  v_xor_b32 v34, 0x10000, v34
  ds_read_b128 v[48:51], v34 offset:32768
  v_xor_b32 v35, 0x10000, v35
  ds_read_b128 v[52:55], v35 offset:32768
  v_xor_b32 v36, 0x10000, v36
  ds_read_b128 v[56:59], v36 offset:32768
  v_xor_b32 v37, 0x10000, v37
  ds_read_b128 v[60:63], v37 offset:32768
  v_xor_b32 v38, 0x10000, v38
  ds_read_b128 v[64:67], v38 offset:32768
  v_xor_b32 v39, 0x10000, v39
  ds_read_b128 v[68:71], v39 offset:32768
  v_xor_b32 v40, 0x10000, v40
  ds_read_b128 v[72:75], v40 offset:32768
  v_xor_b32 v41, 0x10000, v41
  ds_read_b128 v[76:79], v41 offset:32768
  s_add_u32 m0, s14, 0
  s_nop 0
  buffer_load_dwordx4 v14, s[56:59], s13 offen offset:0 nt lds
  s_add_u32 s13, s13, 8192
  s_and_b32 s13, s13, 0x1ffff
  v_fma_f32 v160, v160, s68, v7
  v_fma_f32 v161, v161, s68, v7
  v_fma_f32 v162, v162, s68, v7
  v_fma_f32 v163, v163, s68, v7
  v_exp_f32 v160, v160
  v_exp_f32 v161, v161
  v_exp_f32 v162, v162
  v_exp_f32 v163, v163
  v_add_f32 v8, v8, v160
  v_add_f32 v8, v8, v161
  v_add_f32 v8, v8, v162
  v_add_f32 v8, v8, v163
  v_cvt_pk_bf16_f32 v160, v160, v161
  v_cvt_pk_bf16_f32 v161, v162, v163
  s_waitcnt lgkmcnt(7)
  v_mfma_f32_32x32x16_bf16 v[176:191], v[48:51], v[192:195], 0
  v_fma_f32 v164, v164, s68, v7
  v_fma_f32 v165, v165, s68, v7
  v_fma_f32 v166, v166, s68, v7
  v_fma_f32 v167, v167, s68, v7
  v_exp_f32 v164, v164
  s_waitcnt lgkmcnt(6)
  v_mfma_f32_32x32x16_bf16 v[176:191], v[52:55], v[196:199], v[176:191]
  v_exp_f32 v165, v165
  v_exp_f32 v166, v166
  v_exp_f32 v167, v167
  v_add_f32 v8, v8, v164
  v_add_f32 v8, v8, v165
  s_waitcnt lgkmcnt(5)
  v_mfma_f32_32x32x16_bf16 v[176:191], v[56:59], v[200:203], v[176:191]
  v_add_f32 v8, v8, v166
  v_add_f32 v8, v8, v167
  v_cvt_pk_bf16_f32 v162, v164, v165
  v_cvt_pk_bf16_f32 v163, v166, v167
  v_fma_f32 v168, v168, s68, v7
  v_fma_f32 v169, v169, s68, v7
  s_waitcnt lgkmcnt(4)
  v_mfma_f32_32x32x16_bf16 v[176:191], v[60:63], v[204:207], v[176:191]
  v_fma_f32 v170, v170, s68, v7
  v_fma_f32 v171, v171, s68, v7
  v_exp_f32 v168, v168
  v_exp_f32 v169, v169
  v_exp_f32 v170, v170
  s_waitcnt lgkmcnt(3)
  v_mfma_f32_32x32x16_bf16 v[176:191], v[64:67], v[208:211], v[176:191]
  v_exp_f32 v171, v171
  v_add_f32 v8, v8, v168
  v_add_f32 v8, v8, v169
  v_add_f32 v8, v8, v170
  v_add_f32 v8, v8, v171
  s_waitcnt lgkmcnt(2)
  v_mfma_f32_32x32x16_bf16 v[176:191], v[68:71], v[212:215], v[176:191]
  v_cvt_pk_bf16_f32 v164, v168, v169
  v_cvt_pk_bf16_f32 v165, v170, v171
  v_fma_f32 v172, v172, s68, v7
  v_fma_f32 v173, v173, s68, v7
  v_fma_f32 v174, v174, s68, v7
  v_fma_f32 v175, v175, s68, v7
  s_waitcnt lgkmcnt(1)
  v_mfma_f32_32x32x16_bf16 v[176:191], v[72:75], v[216:219], v[176:191]
  v_exp_f32 v172, v172
  v_exp_f32 v173, v173
  v_exp_f32 v174, v174
  v_exp_f32 v175, v175
  s_waitcnt lgkmcnt(0)
  v_mfma_f32_32x32x16_bf16 v[176:191], v[76:79], v[220:223], v[176:191]
  v_add_f32 v8, v8, v172
  v_add_f32 v8, v8, v173
  v_add_f32 v8, v8, v174
  v_add_f32 v8, v8, v175
  v_cvt_pk_bf16_f32 v166, v172, v173
  v_cvt_pk_bf16_f32 v167, v174, v175
  s_waitcnt vmcnt(2)
  s_barrier
  v_xor_b32 v30, 0x10000, v30
  v_xor_b32 v31, 0x10000, v31
  v_xor_b32 v32, 0x10000, v32
  v_xor_b32 v33, 0x10000, v33
  ds_read_b64_tr_b16 v[48:49], v30 offset:0
  ds_read_b64_tr_b16 v[50:51], v30 offset:2048
  ds_read_b64_tr_b16 v[52:53], v31 offset:0
  ds_read_b64_tr_b16 v[54:55], v31 offset:2048
  ds_read_b64_tr_b16 v[56:57], v32 offset:0
  ds_read_b64_tr_b16 v[58:59], v32 offset:2048
  ds_read_b64_tr_b16 v[60:61], v33 offset:0
  ds_read_b64_tr_b16 v[62:63], v33 offset:2048
  ds_read_b64_tr_b16 v[64:65], v30 offset:4096
  ds_read_b64_tr_b16 v[66:67], v30 offset:6144
  ds_read_b64_tr_b16 v[68:69], v31 offset:4096
  ds_read_b64_tr_b16 v[70:71], v31 offset:6144
  ds_read_b64_tr_b16 v[72:73], v32 offset:4096
  ds_read_b64_tr_b16 v[74:75], v32 offset:6144
  ds_read_b64_tr_b16 v[76:77], v33 offset:4096
  ds_read_b64_tr_b16 v[78:79], v33 offset:6144
  s_add_u32 m0, s14, 32768
  s_nop 0
  buffer_load_dwordx4 v22, s[52:55], s12 offen offset:0 nt lds
  s_add_u32 s12, s12, 8192
  s_and_b32 s12, s12, 0x1ffff
  v_max3_f32 v9, v176, v177, v178
  v_max3_f32 v9, v9, v179, v180
  v_max3_f32 v9, v9, v181, v182
  v_max3_f32 v9, v9, v183, v184
  v_max3_f32 v9, v9, v185, v186
  v_max3_f32 v9, v9, v187, v188
  v_max3_f32 v9, v9, v189, v190
  v_max_f32 v9, v9, v191
  s_waitcnt lgkmcnt(14)
  v_mfma_f32_32x32x16_bf16 v[96:111], v[48:51], v[160:163], v[96:111]
  v_mov_b32 v10, v9
  s_waitcnt lgkmcnt(12)
  v_mfma_f32_32x32x16_bf16 v[112:127], v[52:55], v[160:163], v[112:127]
  s_waitcnt lgkmcnt(10)
  v_mfma_f32_32x32x16_bf16 v[128:143], v[56:59], v[160:163], v[128:143]
  v_permlane32_swap_b32 v9, v10
  s_waitcnt lgkmcnt(8)
  v_mfma_f32_32x32x16_bf16 v[144:159], v[60:63], v[160:163], v[144:159]
  s_waitcnt lgkmcnt(6)
  v_mfma_f32_32x32x16_bf16 v[96:111], v[64:67], v[164:167], v[96:111]
  v_max_f32 v9, v9, v10
  s_waitcnt lgkmcnt(4)
  v_mfma_f32_32x32x16_bf16 v[112:127], v[68:71], v[164:167], v[112:127]
  s_waitcnt lgkmcnt(2)
  v_mfma_f32_32x32x16_bf16 v[128:143], v[72:75], v[164:167], v[128:143]
  v_mul_f32 v9, s68, v9
  s_waitcnt lgkmcnt(0)
  v_mfma_f32_32x32x16_bf16 v[144:159], v[76:79], v[164:167], v[144:159]
  v_add_f32 v10, v9, v7
  v_cmp_lt_f32 vcc, 0x41000000, v10
  s_nop 9
  s_cbranch_vccz L_fast_2942
  s_call_b64 s[80:81], L_slow
L_fast_2942:
  s_waitcnt vmcnt(2)
  s_barrier
  v_xor_b32 v34, 0x10000, v34
  ds_read_b128 v[48:51], v34 offset:32768
  v_xor_b32 v35, 0x10000, v35
  ds_read_b128 v[52:55], v35 offset:32768
  v_xor_b32 v36, 0x10000, v36
  ds_read_b128 v[56:59], v36 offset:32768
  v_xor_b32 v37, 0x10000, v37
  ds_read_b128 v[60:63], v37 offset:32768
  v_xor_b32 v38, 0x10000, v38
  ds_read_b128 v[64:67], v38 offset:32768
  v_xor_b32 v39, 0x10000, v39
  ds_read_b128 v[68:71], v39 offset:32768
  v_xor_b32 v40, 0x10000, v40
  ds_read_b128 v[72:75], v40 offset:32768
  v_xor_b32 v41, 0x10000, v41
  ds_read_b128 v[76:79], v41 offset:32768
  s_add_u32 m0, s14, 65536
  s_nop 0
  buffer_load_dwordx4 v14, s[56:59], s13 offen offset:0 nt lds
  s_add_u32 s13, s13, 8192
  s_and_b32 s13, s13, 0x1ffff
  v_fma_f32 v176, v176, s68, v7
  v_fma_f32 v177, v177, s68, v7
  v_fma_f32 v178, v178, s68, v7
  v_fma_f32 v179, v179, s68, v7
  v_exp_f32 v176, v176
  v_exp_f32 v177, v177
  v_exp_f32 v178, v178
  v_exp_f32 v179, v179
  v_add_f32 v8, v8, v176
  v_add_f32 v8, v8, v177
  v_add_f32 v8, v8, v178
  v_add_f32 v8, v8, v179
  v_cvt_pk_bf16_f32 v176, v176, v177
  v_cvt_pk_bf16_f32 v177, v178, v179
  s_waitcnt lgkmcnt(7)
  v_mfma_f32_32x32x16_bf16 v[160:175], v[48:51], v[192:195], 0
  v_fma_f32 v180, v180, s68, v7
  v_fma_f32 v181, v181, s68, v7
  v_fma_f32 v182, v182, s68, v7
  v_fma_f32 v183, v183, s68, v7
  v_exp_f32 v180, v180
  s_waitcnt lgkmcnt(6)
  v_mfma_f32_32x32x16_bf16 v[160:175], v[52:55], v[196:199], v[160:175]
  v_exp_f32 v181, v181
  v_exp_f32 v182, v182
  v_exp_f32 v183, v183
  v_add_f32 v8, v8, v180
  v_add_f32 v8, v8, v181
  s_waitcnt lgkmcnt(5)
  v_mfma_f32_32x32x16_bf16 v[160:175], v[56:59], v[200:203], v[160:175]
  v_add_f32 v8, v8, v182
  v_add_f32 v8, v8, v183
  v_cvt_pk_bf16_f32 v178, v180, v181
  v_cvt_pk_bf16_f32 v179, v182, v183
  v_fma_f32 v184, v184, s68, v7
  v_fma_f32 v185, v185, s68, v7
  s_waitcnt lgkmcnt(4)
  v_mfma_f32_32x32x16_bf16 v[160:175], v[60:63], v[204:207], v[160:175]
  v_fma_f32 v186, v186, s68, v7
  v_fma_f32 v187, v187, s68, v7
  v_exp_f32 v184, v184
  v_exp_f32 v185, v185
  v_exp_f32 v186, v186
  s_waitcnt lgkmcnt(3)
  v_mfma_f32_32x32x16_bf16 v[160:175], v[64:67], v[208:211], v[160:175]
  v_exp_f32 v187, v187
  v_add_f32 v8, v8, v184
  v_add_f32 v8, v8, v185
  v_add_f32 v8, v8, v186
  v_add_f32 v8, v8, v187
  s_waitcnt lgkmcnt(2)
  v_mfma_f32_32x32x16_bf16 v[160:175], v[68:71], v[212:215], v[160:175]
  v_cvt_pk_bf16_f32 v180, v184, v185
  v_cvt_pk_bf16_f32 v181, v186, v187
  v_fma_f32 v188, v188, s68, v7
  v_fma_f32 v189, v189, s68, v7
  v_fma_f32 v190, v190, s68, v7
  v_fma_f32 v191, v191, s68, v7
  s_waitcnt lgkmcnt(1)
  v_mfma_f32_32x32x16_bf16 v[160:175], v[72:75], v[216:219], v[160:175]
  v_exp_f32 v188, v188
  v_exp_f32 v189, v189
  v_exp_f32 v190, v190
  v_exp_f32 v191, v191
  s_waitcnt lgkmcnt(0)
  v_mfma_f32_32x32x16_bf16 v[160:175], v[76:79], v[220:223], v[160:175]
  v_add_f32 v8, v8, v188
  v_add_f32 v8, v8, v189
  v_add_f32 v8, v8, v190
  v_add_f32 v8, v8, v191
  v_cvt_pk_bf16_f32 v182, v188, v189
  v_cvt_pk_bf16_f32 v183, v190, v191
  s_waitcnt vmcnt(2)
  s_barrier
  v_xor_b32 v30, 0x10000, v30
  v_xor_b32 v31, 0x10000, v31
  v_xor_b32 v32, 0x10000, v32
  v_xor_b32 v33, 0x10000, v33
  ds_read_b64_tr_b16 v[48:49], v30 offset:0
  ds_read_b64_tr_b16 v[50:51], v30 offset:2048
  ds_read_b64_tr_b16 v[52:53], v31 offset:0
  ds_read_b64_tr_b16 v[54:55], v31 offset:2048
  ds_read_b64_tr_b16 v[56:57], v32 offset:0
  ds_read_b64_tr_b16 v[58:59], v32 offset:2048
  ds_read_b64_tr_b16 v[60:61], v33 offset:0
  ds_read_b64_tr_b16 v[62:63], v33 offset:2048
  ds_read_b64_tr_b16 v[64:65], v30 offset:4096
  ds_read_b64_tr_b16 v[66:67], v30 offset:6144
  ds_read_b64_tr_b16 v[68:69], v31 offset:4096
  ds_read_b64_tr_b16 v[70:71], v31 offset:6144
  ds_read_b64_tr_b16 v[72:73], v32 offset:4096
  ds_read_b64_tr_b16 v[74:75], v32 offset:6144
  ds_read_b64_tr_b16 v[76:77], v33 offset:4096
  ds_read_b64_tr_b16 v[78:79], v33 offset:6144
  s_add_u32 m0, s14, 98304
  s_nop 0
  buffer_load_dwordx4 v22, s[52:55], s12 offen offset:0 nt lds
  s_add_u32 s12, s12, 8192
  s_and_b32 s12, s12, 0x1ffff
  v_max3_f32 v9, v160, v161, v162
  v_max3_f32 v9, v9, v163, v164
  v_max3_f32 v9, v9, v165, v166
  v_max3_f32 v9, v9, v167, v168
  v_max3_f32 v9, v9, v169, v170
  v_max3_f32 v9, v9, v171, v172
  v_max3_f32 v9, v9, v173, v174
  v_max_f32 v9, v9, v175
  s_waitcnt lgkmcnt(14)
  v_mfma_f32_32x32x16_bf16 v[96:111], v[48:51], v[176:179], v[96:111]
  v_mov_b32 v10, v9
  s_waitcnt lgkmcnt(12)
  v_mfma_f32_32x32x16_bf16 v[112:127], v[52:55], v[176:179], v[112:127]
  s_waitcnt lgkmcnt(10)
  v_mfma_f32_32x32x16_bf16 v[128:143], v[56:59], v[176:179], v[128:143]
  v_permlane32_swap_b32 v9, v10
  s_waitcnt lgkmcnt(8)
  v_mfma_f32_32x32x16_bf16 v[144:159], v[60:63], v[176:179], v[144:159]
  s_waitcnt lgkmcnt(6)
  v_mfma_f32_32x32x16_bf16 v[96:111], v[64:67], v[180:183], v[96:111]
  v_max_f32 v9, v9, v10
  s_waitcnt lgkmcnt(4)
  v_mfma_f32_32x32x16_bf16 v[112:127], v[68:71], v[180:183], v[112:127]
  s_waitcnt lgkmcnt(2)
  v_mfma_f32_32x32x16_bf16 v[128:143], v[72:75], v[180:183], v[128:143]
  v_mul_f32 v9, s68, v9
  s_waitcnt lgkmcnt(0)
  v_mfma_f32_32x32x16_bf16 v[144:159], v[76:79], v[180:183], v[144:159]
  v_add_f32 v10, v9, v7
  v_cmp_lt_f32 vcc, 0x41000000, v10
  s_nop 9
  s_cbranch_vccz L_fast_3097
  s_call_b64 s[80:81], L_slow
L_fast_3097:
  s_sub_u32 s11, s11, 1
  s_cmp_lg_u32 s11, 0
  s_nop 1
  s_cbranch_scc1 L_attA
  s_waitcnt vmcnt(2)
  s_barrier
  v_xor_b32 v34, 0x10000, v34
  ds_read_b128 v[48:51], v34 offset:32768
  v_xor_b32 v35, 0x10000, v35
  ds_read_b128 v[52:55], v35 offset:32768
  v_xor_b32 v36, 0x10000, v36
  ds_read_b128 v[56:59], v36 offset:32768
  v_xor_b32 v37, 0x10000, v37
  ds_read_b128 v[60:63], v37 offset:32768
  v_xor_b32 v38, 0x10000, v38
  ds_read_b128 v[64:67], v38 offset:32768
  v_xor_b32 v39, 0x10000, v39
  ds_read_b128 v[68:71], v39 offset:32768
  v_xor_b32 v40, 0x10000, v40
  ds_read_b128 v[72:75], v40 offset:32768
  v_xor_b32 v41, 0x10000, v41
  ds_read_b128 v[76:79], v41 offset:32768
  s_add_u32 m0, s14, 0
  s_nop 0
  buffer_load_dwordx4 v14, s[56:59], s13 offen offset:0 nt lds
  s_add_u32 s13, s13, 8192
  s_and_b32 s13, s13, 0x1ffff
  v_fma_f32 v160, v160, s68, v7
  v_fma_f32 v161, v161, s68, v7
  v_fma_f32 v162, v162, s68, v7
  v_fma_f32 v163, v163, s68, v7
  v_exp_f32 v160, v160
  v_exp_f32 v161, v161
  v_exp_f32 v162, v162
  v_exp_f32 v163, v163
  v_add_f32 v8, v8, v160
  v_add_f32 v8, v8, v161
  v_add_f32 v8, v8, v162
  v_add_f32 v8, v8, v163
  v_cvt_pk_bf16_f32 v160, v160, v161
  v_cvt_pk_bf16_f32 v161, v162, v163
  s_waitcnt lgkmcnt(7)
  v_mfma_f32_32x32x16_bf16 v[176:191], v[48:51], v[192:195], 0
  v_fma_f32 v164, v164, s68, v7
  v_fma_f32 v165, v165, s68, v7
  v_fma_f32 v166, v166, s68, v7
  v_fma_f32 v167, v167, s68, v7
  v_exp_f32 v164, v164
  s_waitcnt lgkmcnt(6)
  v_mfma_f32_32x32x16_bf16 v[176:191], v[52:55], v[196:199], v[176:191]
  v_exp_f32 v165, v165
  v_exp_f32 v166, v166
  v_exp_f32 v167, v167
  v_add_f32 v8, v8, v164
  v_add_f32 v8, v8, v165
  s_waitcnt lgkmcnt(5)
  v_mfma_f32_32x32x16_bf16 v[176:191], v[56:59], v[200:203], v[176:191]
  v_add_f32 v8, v8, v166
  v_add_f32 v8, v8, v167
  v_cvt_pk_bf16_f32 v162, v164, v165
  v_cvt_pk_bf16_f32 v163, v166, v167
  v_fma_f32 v168, v168, s68, v7
  v_fma_f32 v169, v169, s68, v7
  s_waitcnt lgkmcnt(4)
  v_mfma_f32_32x32x16_bf16 v[176:191], v[60:63], v[204:207], v[176:191]
  v_fma_f32 v170, v170, s68, v7
  v_fma_f32 v171, v171, s68, v7
  v_exp_f32 v168, v168
  v_exp_f32 v169, v169
  v_exp_f32 v170, v170
  s_waitcnt lgkmcnt(3)
  v_mfma_f32_32x32x16_bf16 v[176:191], v[64:67], v[208:211], v[176:191]
  v_exp_f32 v171, v171
  v_add_f32 v8, v8, v168
  v_add_f32 v8, v8, v169
  v_add_f32 v8, v8, v170
  v_add_f32 v8, v8, v171
  s_waitcnt lgkmcnt(2)
  v_mfma_f32_32x32x16_bf16 v[176:191], v[68:71], v[212:215], v[176:191]
  v_cvt_pk_bf16_f32 v164, v168, v169
  v_cvt_pk_bf16_f32 v165, v170, v171
  v_fma_f32 v172, v172, s68, v7
  v_fma_f32 v173, v173, s68, v7
  v_fma_f32 v174, v174, s68, v7
  v_fma_f32 v175, v175, s68, v7
  s_waitcnt lgkmcnt(1)
  v_mfma_f32_32x32x16_bf16 v[176:191], v[72:75], v[216:219], v[176:191]
  v_exp_f32 v172, v172
  v_exp_f32 v173, v173
  v_exp_f32 v174, v174
  v_exp_f32 v175, v175
  s_waitcnt lgkmcnt(0)
  v_mfma_f32_32x32x16_bf16 v[176:191], v[76:79], v[220:223], v[176:191]
  v_add_f32 v8, v8, v172
  v_add_f32 v8, v8, v173
  v_add_f32 v8, v8, v174
  v_add_f32 v8, v8, v175
  v_cvt_pk_bf16_f32 v166, v172, v173
  v_cvt_pk_bf16_f32 v167, v174, v175
  s_waitcnt vmcnt(2)
  s_barrier
  v_xor_b32 v30, 0x10000, v30
  v_xor_b32 v31, 0x10000, v31
  v_xor_b32 v32, 0x10000, v32
  v_xor_b32 v33, 0x10000, v33
  ds_read_b64_tr_b16 v[48:49], v30 offset:0
  ds_read_b64_tr_b16 v[50:51], v30 offset:2048
  ds_read_b64_tr_b16 v[52:53], v31 offset:0
  ds_read_b64_tr_b16 v[54:55], v31 offset:2048
  ds_read_b64_tr_b16 v[56:57], v32 offset:0
  ds_read_b64_tr_b16 v[58:59], v32 offset:2048
  ds_read_b64_tr_b16 v[60:61], v33 offset:0
  ds_read_b64_tr_b16 v[62:63], v33 offset:2048
  ds_read_b64_tr_b16 v[64:65], v30 offset:4096
  ds_read_b64_tr_b16 v[66:67], v30 offset:6144
  ds_read_b64_tr_b16 v[68:69], v31 offset:4096
  ds_read_b64_tr_b16 v[70:71], v31 offset:6144
  ds_read_b64_tr_b16 v[72:73], v32 offset:4096
  ds_read_b64_tr_b16 v[74:75], v32 offset:6144
  ds_read_b64_tr_b16 v[76:77], v33 offset:4096
  ds_read_b64_tr_b16 v[78:79], v33 offset:6144
  s_add_u32 m0, s14, 32768
  s_nop 0
  buffer_load_dwordx4 v22, s[52:55], s12 offen offset:0 nt lds
  s_add_u32 s12, s12, 8192
  s_and_b32 s12, s12, 0x1ffff
  v_max3_f32 v9, v176, v177, v178
  v_max3_f32 v9, v9, v179, v180
  v_max3_f32 v9, v9, v181, v182
  v_max3_f32 v9, v9, v183, v184
  v_max3_f32 v9, v9, v185, v186
  v_max3_f32 v9, v9, v187, v188
  v_max3_f32 v9, v9, v189, v190
  v_max_f32 v9, v9, v191
  s_waitcnt lgkmcnt(14)
  v_mfma_f32_32x32x16_bf16 v[96:111], v[48:51], v[160:163], v[96:111]
  v_mov_b32 v10, v9
  s_waitcnt lgkmcnt(12)
  v_mfma_f32_32x32x16_bf16 v[112:127], v[52:55], v[160:163], v[112:127]
  s_waitcnt lgkmcnt(10)
  v_mfma_f32_32x32x16_bf16 v[128:143], v[56:59], v[160:163], v[128:143]
  v_permlane32_swap_b32 v9, v10
  s_waitcnt lgkmcnt(8)
  v_mfma_f32_32x32x16_bf16 v[144:159], v[60:63], v[160:163], v[144:159]
  s_waitcnt lgkmcnt(6)
  v_mfma_f32_32x32x16_bf16 v[96:111], v[64:67], v[164:167], v[96:111]
  v_max_f32 v9, v9, v10
  s_waitcnt lgkmcnt(4)
  v_mfma_f32_32x32x16_bf16 v[112:127], v[68:71], v[164:167], v[112:127]
  s_waitcnt lgkmcnt(2)
  v_mfma_f32_32x32x16_bf16 v[128:143], v[72:75], v[164:167], v[128:143]
  v_mul_f32 v9, s68, v9
  s_waitcnt lgkmcnt(0)
  v_mfma_f32_32x32x16_bf16 v[144:159], v[76:79], v[164:167], v[144:159]
  v_add_f32 v10, v9, v7
  v_cmp_lt_f32 vcc, 0x41000000, v10
  s_nop 9
  s_cbranch_vccz L_fast_3256
  s_call_b64 s[80:81], L_slow
L_fast_3256:
  s_mov_b32 s10, s4
  s_mov_b32 s78, s4
  s_lshl_b32 s77, s5, 19
  s_add_u32 s77, s77, s75
  v_xor_b32 v18, 0, v2
  v_xor_b32 v19, 64, v2
  v_xor_b32 v20, 128, v2
  v_xor_b32 v21, 192, v2
  s_waitcnt vmcnt(2)
  s_barrier
  v_xor_b32 v34, 0x10000, v34
  ds_read_b128 v[48:51], v34 offset:32768
  v_xor_b32 v35, 0x10000, v35
  ds_read_b128 v[52:55], v35 offset:32768
  v_xor_b32 v36, 0x10000, v36
  ds_read_b128 v[56:59], v36 offset:32768
  v_xor_b32 v37, 0x10000, v37
  ds_read_b128 v[60:63], v37 offset:32768
  v_xor_b32 v38, 0x10000, v38
  ds_read_b128 v[64:67], v38 offset:32768
  v_xor_b32 v39, 0x10000, v39
  ds_read_b128 v[68:71], v39 offset:32768
  v_xor_b32 v40, 0x10000, v40
  ds_read_b128 v[72:75], v40 offset:32768
  v_xor_b32 v41, 0x10000, v41
  ds_read_b128 v[76:79], v41 offset:32768
  s_add_u32 m0, s14, 65536
  s_nop 0
  buffer_load_dwordx4 v14, s[56:59], s13 offen offset:0 nt lds
  s_add_u32 s13, s13, 8192
  s_and_b32 s13, s13, 0x1ffff
  v_fma_f32 v176, v176, s68, v7
  v_fma_f32 v177, v177, s68, v7
  v_fma_f32 v178, v178, s68, v7
  v_fma_f32 v179, v179, s68, v7
  v_exp_f32 v176, v176
  v_exp_f32 v177, v177
  v_exp_f32 v178, v178
  v_exp_f32 v179, v179
  v_add_f32 v8, v8, v176
  v_add_f32 v8, v8, v177
  v_add_f32 v8, v8, v178
  v_add_f32 v8, v8, v179
  v_cvt_pk_bf16_f32 v176, v176, v177
  v_cvt_pk_bf16_f32 v177, v178, v179
  s_waitcnt lgkmcnt(7)
  v_mfma_f32_32x32x16_bf16 v[160:175], v[48:51], v[192:195], 0
  v_fma_f32 v180, v180, s68, v7
  v_fma_f32 v181, v181, s68, v7
  v_fma_f32 v182, v182, s68, v7
  v_fma_f32 v183, v183, s68, v7
  v_exp_f32 v180, v180
  s_waitcnt lgkmcnt(6)
  v_mfma_f32_32x32x16_bf16 v[160:175], v[52:55], v[196:199], v[160:175]
  v_exp_f32 v181, v181
  v_exp_f32 v182, v182
  v_exp_f32 v183, v183
  v_add_f32 v8, v8, v180
  v_add_f32 v8, v8, v181
  s_waitcnt lgkmcnt(5)
  v_mfma_f32_32x32x16_bf16 v[160:175], v[56:59], v[200:203], v[160:175]
  v_add_f32 v8, v8, v182
  v_add_f32 v8, v8, v183
  v_cvt_pk_bf16_f32 v178, v180, v181
  v_cvt_pk_bf16_f32 v179, v182, v183
  v_fma_f32 v184, v184, s68, v7
  v_fma_f32 v185, v185, s68, v7
  s_waitcnt lgkmcnt(4)
  v_mfma_f32_32x32x16_bf16 v[160:175], v[60:63], v[204:207], v[160:175]
  v_fma_f32 v186, v186, s68, v7
  v_fma_f32 v187, v187, s68, v7
  v_exp_f32 v184, v184
  v_exp_f32 v185, v185
  v_exp_f32 v186, v186
  s_waitcnt lgkmcnt(3)
  v_mfma_f32_32x32x16_bf16 v[160:175], v[64:67], v[208:211], v[160:175]
  v_exp_f32 v187, v187
  v_add_f32 v8, v8, v184
  v_add_f32 v8, v8, v185
  v_add_f32 v8, v8, v186
  v_add_f32 v8, v8, v187
  s_waitcnt lgkmcnt(2)
  v_mfma_f32_32x32x16_bf16 v[160:175], v[68:71], v[212:215], v[160:175]
  v_cvt_pk_bf16_f32 v180, v184, v185
  v_cvt_pk_bf16_f32 v181, v186, v187
  v_fma_f32 v188, v188, s68, v7
  v_fma_f32 v189, v189, s68, v7
  v_fma_f32 v190, v190, s68, v7
  v_fma_f32 v191, v191, s68, v7
  s_waitcnt lgkmcnt(1)
  v_mfma_f32_32x32x16_bf16 v[160:175], v[72:75], v[216:219], v[160:175]
  v_exp_f32 v188, v188
  v_exp_f32 v189, v189
  v_exp_f32 v190, v190
  v_exp_f32 v191, v191
  s_waitcnt lgkmcnt(0)
  v_mfma_f32_32x32x16_bf16 v[160:175], v[76:79], v[220:223], v[160:175]
  v_add_f32 v8, v8, v188
  v_add_f32 v8, v8, v189
  v_add_f32 v8, v8, v190
  v_add_f32 v8, v8, v191
  v_cvt_pk_bf16_f32 v182, v188, v189
  v_cvt_pk_bf16_f32 v183, v190, v191
  s_waitcnt vmcnt(2)
  s_barrier
  v_xor_b32 v30, 0x10000, v30
  v_xor_b32 v31, 0x10000, v31
  v_xor_b32 v32, 0x10000, v32
  v_xor_b32 v33, 0x10000, v33
  ds_read_b64_tr_b16 v[48:49], v30 offset:0
  ds_read_b64_tr_b16 v[50:51], v30 offset:2048
  ds_read_b64_tr_b16 v[52:53], v31 offset:0
  ds_read_b64_tr_b16 v[54:55], v31 offset:2048
  ds_read_b64_tr_b16 v[56:57], v32 offset:0
  ds_read_b64_tr_b16 v[58:59], v32 offset:2048
  ds_read_b64_tr_b16 v[60:61], v33 offset:0
  ds_read_b64_tr_b16 v[62:63], v33 offset:2048
  ds_read_b64_tr_b16 v[64:65], v30 offset:4096
  ds_read_b64_tr_b16 v[66:67], v30 offset:6144
  ds_read_b64_tr_b16 v[68:69], v31 offset:4096
  ds_read_b64_tr_b16 v[70:71], v31 offset:6144
  ds_read_b64_tr_b16 v[72:73], v32 offset:4096
  ds_read_b64_tr_b16 v[74:75], v32 offset:6144
  ds_read_b64_tr_b16 v[76:77], v33 offset:4096
  ds_read_b64_tr_b16 v[78:79], v33 offset:6144
  s_add_u32 m0, s14, 98304
  s_nop 0
  buffer_load_dwordx4 v14, s[56:59], s13 offen offset:0 nt lds
  s_add_u32 s13, s13, 8192
  s_and_b32 s13, s13, 0x1ffff
  v_max3_f32 v9, v160, v161, v162
  v_max3_f32 v9, v9, v163, v164
  v_max3_f32 v9, v9, v165, v166
  v_max3_f32 v9, v9, v167, v168
  v_max3_f32 v9, v9, v169, v170
  v_max3_f32 v9, v9, v171, v172
  v_max3_f32 v9, v9, v173, v174
  v_max_f32 v9, v9, v175
  s_waitcnt lgkmcnt(14)
  v_mfma_f32_32x32x16_bf16 v[96:111], v[48:51], v[176:179], v[96:111]
  v_mov_b32 v10, v9
  s_waitcnt lgkmcnt(12)
  v_mfma_f32_32x32x16_bf16 v[112:127], v[52:55], v[176:179], v[112:127]
  s_waitcnt lgkmcnt(10)
  v_mfma_f32_32x32x16_bf16 v[128:143], v[56:59], v[176:179], v[128:143]
  v_permlane32_swap_b32 v9, v10
  s_waitcnt lgkmcnt(8)
  v_mfma_f32_32x32x16_bf16 v[144:159], v[60:63], v[176:179], v[144:159]
  s_waitcnt lgkmcnt(6)
  v_mfma_f32_32x32x16_bf16 v[96:111], v[64:67], v[180:183], v[96:111]
  v_max_f32 v9, v9, v10
  s_waitcnt lgkmcnt(4)
  v_mfma_f32_32x32x16_bf16 v[112:127], v[68:71], v[180:183], v[112:127]
  s_waitcnt lgkmcnt(2)
  v_mfma_f32_32x32x16_bf16 v[128:143], v[72:75], v[180:183], v[128:143]
  v_mul_f32 v9, s68, v9
  s_waitcnt lgkmcnt(0)
  v_mfma_f32_32x32x16_bf16 v[144:159], v[76:79], v[180:183], v[144:159]
  v_add_f32 v10, v9, v7
  v_cmp_lt_f32 vcc, 0x41000000, v10
  s_nop 9
  s_cbranch_vccz L_fast_3419
  s_call_b64 s[80:81], L_slow
L_fast_3419:
  s_waitcnt vmcnt(2)
  s_barrier
  v_xor_b32 v34, 0x10000, v34
  ds_read_b128 v[48:51], v34 offset:32768
  v_xor_b32 v35, 0x10000, v35
  ds_read_b128 v[52:55], v35 offset:32768
  v_xor_b32 v36, 0x10000, v36
  ds_read_b128 v[56:59], v36 offset:32768
  v_xor_b32 v37, 0x10000, v37
  ds_read_b128 v[60:63], v37 offset:32768
  v_xor_b32 v38, 0x10000, v38
  ds_read_b128 v[64:67], v38 offset:32768
  v_xor_b32 v39, 0x10000, v39
  ds_read_b128 v[68:71], v39 offset:32768
  v_xor_b32 v40, 0x10000, v40
  ds_read_b128 v[72:75], v40 offset:32768
  v_xor_b32 v41, 0x10000, v41
  ds_read_b128 v[76:79], v41 offset:32768
  s_lshl_b32 s69, s10, 15
  s_add_u32 s69, s69, s77
  s_add_u32 m0, s75, 0
  s_add_u32 s10, s10, 1
  s_and_b32 s10, s10, 15
  buffer_load_dwordx4 v18, s[60:63], s69 offen offset:0 lds
  buffer_load_dwordx4 v19, s[60:63], s69 offen offset:1024 lds
  v_fma_f32 v160, v160, s68, v7
  v_fma_f32 v161, v161, s68, v7
  v_fma_f32 v162, v162, s68, v7
  v_fma_f32 v163, v163, s68, v7
  v_exp_f32 v160, v160
  v_exp_f32 v161, v161
  v_exp_f32 v162, v162
  v_exp_f32 v163, v163
  v_add_f32 v8, v8, v160
  v_add_f32 v8, v8, v161
  v_add_f32 v8, v8, v162
  v_add_f32 v8, v8, v163
  v_cvt_pk_bf16_f32 v160, v160, v161
  v_cvt_pk_bf16_f32 v161, v162, v163
  s_waitcnt lgkmcnt(7)
  v_mfma_f32_32x32x16_bf16 v[176:191], v[48:51], v[192:195], 0
  buffer_load_dwordx4 v20, s[60:63], s69 offen offset:2048 lds
  buffer_load_dwordx4 v21, s[60:63], s69 offen offset:3072 lds
  v_fma_f32 v164, v164, s68, v7
  v_fma_f32 v165, v165, s68, v7
  v_fma_f32 v166, v166, s68, v7
  s_waitcnt lgkmcnt(6)
  v_mfma_f32_32x32x16_bf16 v[176:191], v[52:55], v[196:199], v[176:191]
  v_fma_f32 v167, v167, s68, v7
  v_exp_f32 v164, v164
  v_exp_f32 v165, v165
  v_exp_f32 v166, v166
  s_waitcnt lgkmcnt(5)
  v_mfma_f32_32x32x16_bf16 v[176:191], v[56:59], v[200:203], v[176:191]
  v_exp_f32 v167, v167
  v_add_f32 v8, v8, v164
  v_add_f32 v8, v8, v165
  v_add_f32 v8, v8, v166
  v_add_f32 v8, v8, v167
  v_cvt_pk_bf16_f32 v162, v164, v165
  v_cvt_pk_bf16_f32 v163, v166, v167
  s_waitcnt lgkmcnt(4)
  v_mfma_f32_32x32x16_bf16 v[176:191], v[60:63], v[204:207], v[176:191]
  v_fma_f32 v168, v168, s68, v7
  v_fma_f32 v169, v169, s68, v7
  v_fma_f32 v170, v170, s68, v7
  v_fma_f32 v171, v171, s68, v7
  v_exp_f32 v168, v168
  v_exp_f32 v169, v169
  s_waitcnt lgkmcnt(3)
  v_mfma_f32_32x32x16_bf16 v[176:191], v[64:67], v[208:211], v[176:191]
  v_exp_f32 v170, v170
  v_exp_f32 v171, v171
  v_add_f32 v8, v8, v168
  v_add_f32 v8, v8, v169
  s_waitcnt lgkmcnt(2)
  v_mfma_f32_32x32x16_bf16 v[176:191], v[68:71], v[212:215], v[176:191]
  v_add_f32 v8, v8, v170
  v_add_f32 v8, v8, v171
  v_cvt_pk_bf16_f32 v164, v168, v169
  v_cvt_pk_bf16_f32 v165, v170, v171
  v_fma_f32 v172, v172, s68, v7
  v_fma_f32 v173, v173, s68, v7
  v_fma_f32 v174, v174, s68, v7
  v_fma_f32 v175, v175, s68, v7
  s_waitcnt lgkmcnt(1)
  v_mfma_f32_32x32x16_bf16 v[176:191], v[72:75], v[216:219], v[176:191]
  v_exp_f32 v172, v172
  v_exp_f32 v173, v173
  v_exp_f32 v174, v174
  s_waitcnt lgkmcnt(0)
  v_mfma_f32_32x32x16_bf16 v[176:191], v[76:79], v[220:223], v[176:191]
  v_exp_f32 v175, v175
  v_add_f32 v8, v8, v172
  v_add_f32 v8, v8, v173
  v_add_f32 v8, v8, v174
  v_add_f32 v8, v8, v175
  v_cvt_pk_bf16_f32 v166, v172, v173
  v_cvt_pk_bf16_f32 v167, v174, v175
  s_waitcnt vmcnt(5)
  s_barrier
  v_xor_b32 v30, 0x10000, v30
  v_xor_b32 v31, 0x10000, v31
  v_xor_b32 v32, 0x10000, v32
  v_xor_b32 v33, 0x10000, v33
  ds_read_b64_tr_b16 v[48:49], v30 offset:0
  ds_read_b64_tr_b16 v[50:51], v30 offset:2048
  ds_read_b64_tr_b16 v[52:53], v31 offset:0
  ds_read_b64_tr_b16 v[54:55], v31 offset:2048
  ds_read_b64_tr_b16 v[56:57], v32 offset:0
  ds_read_b64_tr_b16 v[58:59], v32 offset:2048
  ds_read_b64_tr_b16 v[60:61], v33 offset:0
  ds_read_b64_tr_b16 v[62:63], v33 offset:2048
  ds_read_b64_tr_b16 v[64:65], v30 offset:4096
  ds_read_b64_tr_b16 v[66:67], v30 offset:6144
  ds_read_b64_tr_b16 v[68:69], v31 offset:4096
  ds_read_b64_tr_b16 v[70:71], v31 offset:6144
  ds_read_b64_tr_b16 v[72:73], v32 offset:4096
  ds_read_b64_tr_b16 v[74:75], v32 offset:6144
  ds_read_b64_tr_b16 v[76:77], v33 offset:4096
  ds_read_b64_tr_b16 v[78:79], v33 offset:6144
  s_lshl_b32 s69, s10, 15
  s_add_u32 s69, s69, s77
  s_add_u32 m0, s75, 32768
  s_add_u32 s10, s10, 1
  s_and_b32 s10, s10, 15
  buffer_load_dwordx4 v18, s[60:63], s69 offen offset:0 lds
  buffer_load_dwordx4 v19, s[60:63], s69 offen offset:1024 lds
  v_max3_f32 v9, v176, v177, v178
  v_max3_f32 v9, v9, v179, v180
  v_max3_f32 v9, v9, v181, v182
  v_max3_f32 v9, v9, v183, v184
  v_max3_f32 v9, v9, v185, v186
  v_max3_f32 v9, v9, v187, v188
  v_max3_f32 v9, v9, v189, v190
  v_max_f32 v9, v9, v191
  s_waitcnt lgkmcnt(14)
  v_mfma_f32_32x32x16_bf16 v[96:111], v[48:51], v[160:163], v[96:111]
  buffer_load_dwordx4 v20, s[60:63], s69 offen offset:2048 lds
  s_waitcnt lgkmcnt(12)
  v_mfma_f32_32x32x16_bf16 v[112:127], v[52:55], v[160:163], v[112:127]
  s_waitcnt lgkmcnt(10)
  v_mfma_f32_32x32x16_bf16 v[128:143], v[56:59], v[160:163], v[128:143]
  buffer_load_dwordx4 v21, s[60:63], s69 offen offset:3072 lds
  s_waitcnt lgkmcnt(8)
  v_mfma_f32_32x32x16_bf16 v[144:159], v[60:63], v[160:163], v[144:159]
  s_waitcnt lgkmcnt(6)
  v_mfma_f32_32x32x16_bf16 v[96:111], v[64:67], v[164:167], v[96:111]
  v_mov_b32 v10, v9
  s_waitcnt lgkmcnt(4)
  v_mfma_f32_32x32x16_bf16 v[112:127], v[68:71], v[164:167], v[112:127]
  v_permlane32_swap_b32 v9, v10
  s_waitcnt lgkmcnt(2)
  v_mfma_f32_32x32x16_bf16 v[128:143], v[72:75], v[164:167], v[128:143]
  v_max_f32 v9, v9, v10
  s_waitcnt lgkmcnt(0)
  v_mfma_f32_32x32x16_bf16 v[144:159], v[76:79], v[164:167], v[144:159]
  v_mul_f32 v9, s68, v9
  v_add_f32 v10, v9, v7
  v_cmp_lt_f32 vcc, 0x41000000, v10
  s_nop 8
  s_cbranch_vccz L_fast_3582
  s_call_b64 s[80:81], L_slow
L_fast_3582:
  v_fma_f32 v176, v176, s68, v7
  v_fma_f32 v177, v177, s68, v7
  v_fma_f32 v178, v178, s68, v7
  v_fma_f32 v179, v179, s68, v7
  v_exp_f32 v176, v176
  v_exp_f32 v177, v177
  v_exp_f32 v178, v178
  v_exp_f32 v179, v179
  v_add_f32 v8, v8, v176
  v_add_f32 v8, v8, v177
  v_add_f32 v8, v8, v178
  v_add_f32 v8, v8, v179
  v_cvt_pk_bf16_f32 v176, v176, v177
  v_cvt_pk_bf16_f32 v177, v178, v179
  v_fma_f32 v180, v180, s68, v7
  v_fma_f32 v181, v181, s68, v7
  v_fma_f32 v182, v182, s68, v7
  v_fma_f32 v183, v183, s68, v7
  v_exp_f32 v180, v180
  v_exp_f32 v181, v181
  v_exp_f32 v182, v182
  v_exp_f32 v183, v183
  v_add_f32 v8, v8, v180
  v_add_f32 v8, v8, v181
  v_add_f32 v8, v8, v182
  v_add_f32 v8, v8, v183
  v_cvt_pk_bf16_f32 v178, v180, v181
  v_cvt_pk_bf16_f32 v179, v182, v183
  v_fma_f32 v184, v184, s68, v7
  v_fma_f32 v185, v185, s68, v7
  v_fma_f32 v186, v186, s68, v7
  v_fma_f32 v187, v187, s68, v7
  v_exp_f32 v184, v184
  v_exp_f32 v185, v185
  v_exp_f32 v186, v186
  v_exp_f32 v187, v187
  v_add_f32 v8, v8, v184
  v_add_f32 v8, v8, v185
  v_add_f32 v8, v8, v186
  v_add_f32 v8, v8, v187
  v_cvt_pk_bf16_f32 v180, v184, v185
  v_cvt_pk_bf16_f32 v181, v186, v187
  v_fma_f32 v188, v188, s68, v7
  v_fma_f32 v189, v189, s68, v7
  v_fma_f32 v190, v190, s68, v7
  v_fma_f32 v191, v191, s68, v7
  v_exp_f32 v188, v188
  v_exp_f32 v189, v189
  v_exp_f32 v190, v190
  v_exp_f32 v191, v191
  v_add_f32 v8, v8, v188
  v_add_f32 v8, v8, v189
  v_add_f32 v8, v8, v190
  v_add_f32 v8, v8, v191
  v_cvt_pk_bf16_f32 v182, v188, v189
  v_cvt_pk_bf16_f32 v183, v190, v191
  v_lshl_add_u32 v10, v3, 2, v5
  v_lshlrev_b32 v10, 10, v10
  v_add_u32 v10, v10, v15
  s_lshl_b32 s69, s8, 8
  v_add_u32 v10, s69, v10
  s_lshl_b32 s69, s9, 1
  s_add_u32 s70, s69, 0
  v_xor_b32 v6, s70, v5
  v_lshl_add_u32 v26, v6, 6, v10
  v_add_u32 v28, 0x10000, v26
  s_add_u32 s70, s69, 1
  v_xor_b32 v6, s70, v5
  v_lshl_add_u32 v27, v6, 6, v10
  v_add_u32 v29, 0x10000, v27
  v_mov_b32 v10, v8
  s_nop 1
  v_permlane32_swap_b32 v8, v10
  v_add_f32 v8, v8, v10
  v_rcp_f32 v11, v8
  s_lshl_b32 s69, s8, 14
  s_lshl_b32 s70, s9, 10
  s_add_u32 s69, s69, s70
  s_add_u32 s69, s69, 98304
  v_add_u32 v13, s69, v2
  s_waitcnt vmcnt(8)
  s_barrier
  ds_read_b64_tr_b16 v[48:49], v30 offset:32768
  ds_read_b64_tr_b16 v[50:51], v30 offset:34816
  ds_read_b64_tr_b16 v[52:53], v31 offset:32768
  ds_read_b64_tr_b16 v[54:55], v31 offset:34816
  ds_read_b64_tr_b16 v[56:57], v32 offset:32768
  ds_read_b64_tr_b16 v[58:59], v32 offset:34816
  ds_read_b64_tr_b16 v[60:61], v33 offset:32768
  ds_read_b64_tr_b16 v[62:63], v33 offset:34816
  ds_read_b64_tr_b16 v[64:65], v30 offset:36864
  ds_read_b64_tr_b16 v[66:67], v30 offset:38912
  ds_read_b64_tr_b16 v[68:69], v31 offset:36864
  ds_read_b64_tr_b16 v[70:71], v31 offset:38912
  ds_read_b64_tr_b16 v[72:73], v32 offset:36864
  ds_read_b64_tr_b16 v[74:75], v32 offset:38912
  ds_read_b64_tr_b16 v[76:77], v33 offset:36864
  ds_read_b64_tr_b16 v[78:79], v33 offset:38912
  s_lshl_b32 s69, s10, 15
  s_add_u32 s69, s69, s77
  s_add_u32 m0, s75, 65536
  s_add_u32 s10, s10, 1
  s_and_b32 s10, s10, 15
  buffer_load_dwordx4 v18, s[60:63], s69 offen offset:0 lds
  buffer_load_dwordx4 v19, s[60:63], s69 offen offset:1024 lds
  s_waitcnt lgkmcnt(14)
  v_mfma_f32_32x32x16_bf16 v[96:111], v[48:51], v[176:179], v[96:111]
  s_waitcnt lgkmcnt(12)
  v_mfma_f32_32x32x16_bf16 v[112:127], v[52:55], v[176:179], v[112:127]
  buffer_load_dwordx4 v20, s[60:63], s69 offen offset:2048 lds
  s_waitcnt lgkmcnt(10)
  v_mfma_f32_32x32x16_bf16 v[128:143], v[56:59], v[176:179], v[128:143]
  s_waitcnt lgkmcnt(8)
  v_mfma_f32_32x32x16_bf16 v[144:159], v[60:63], v[176:179], v[144:159]
  s_waitcnt lgkmcnt(6)
  v_mfma_f32_32x32x16_bf16 v[96:111], v[64:67], v[180:183], v[96:111]
  s_waitcnt lgkmcnt(4)
  v_mfma_f32_32x32x16_bf16 v[112:127], v[68:71], v[180:183], v[112:127]
  buffer_load_dwordx4 v21, s[60:63], s69 offen offset:3072 lds
  s_waitcnt lgkmcnt(2)
  v_mfma_f32_32x32x16_bf16 v[128:143], v[72:75], v[180:183], v[128:143]
  s_waitcnt lgkmcnt(0)
  v_mfma_f32_32x32x16_bf16 v[144:159], v[76:79], v[180:183], v[144:159]
  s_nop 11
L_join:
  s_barrier
  v_mul_f32 v96, v96, v11
  v_mul_f32 v97, v97, v11
  v_mul_f32 v98, v98, v11
  v_mul_f32 v99, v99, v11
  v_mul_f32 v100, v100, v11
  v_mul_f32 v101, v101, v11
  v_mul_f32 v102, v102, v11
  v_mul_f32 v103, v103, v11
  v_cvt_pk_bf16_f32 v224, v96, v97
  v_cvt_pk_bf16_f32 v225, v98, v99
  v_cvt_pk_bf16_f32 v226, v100, v101
  v_cvt_pk_bf16_f32 v227, v102, v103
  ds_write_b128 v13, v[224:227] offset:0
  v_mul_f32 v104, v104, v11
  v_mul_f32 v105, v105, v11
  v_mul_f32 v106, v106, v11
  v_mul_f32 v107, v107, v11
  v_mul_f32 v108, v108, v11
  v_mul_f32 v109, v109, v11
  v_mul_f32 v110, v110, v11
  v_mul_f32 v111, v111, v11
  v_cvt_pk_bf16_f32 v228, v104, v105
  v_cvt_pk_bf16_f32 v229, v106, v107
  v_cvt_pk_bf16_f32 v230, v108, v109
  v_cvt_pk_bf16_f32 v231, v110, v111
  ds_write_b128 v13, v[228:231] offset:2048
  v_mul_f32 v112, v112, v11
  v_mul_f32 v113, v113, v11
  v_mul_f32 v114, v114, v11
  v_mul_f32 v115, v115, v11
  v_mul_f32 v116, v116, v11
  v_mul_f32 v117, v117, v11
  v_mul_f32 v118, v118, v11
  v_mul_f32 v119, v119, v11
  v_cvt_pk_bf16_f32 v232, v112, v113
  v_cvt_pk_bf16_f32 v233, v114, v115
  v_cvt_pk_bf16_f32 v234, v116, v117
  v_cvt_pk_bf16_f32 v235, v118, v119
  ds_write_b128 v13, v[232:235] offset:4096
  v_mul_f32 v120, v120, v11
  v_mul_f32 v121, v121, v11
  v_mul_f32 v122, v122, v11
  v_mul_f32 v123, v123, v11
  v_mul_f32 v124, v124, v11
  v_mul_f32 v125, v125, v11
  v_mul_f32 v126, v126, v11
  v_mul_f32 v127, v127, v11
  v_cvt_pk_bf16_f32 v236, v120, v121
  v_cvt_pk_bf16_f32 v237, v122, v123
  v_cvt_pk_bf16_f32 v238, v124, v125
  v_cvt_pk_bf16_f32 v239, v126, v127
  ds_write_b128 v13, v[236:239] offset:6144
  v_mul_f32 v128, v128, v11
  v_mul_f32 v129, v129, v11
  v_mul_f32 v130, v130, v11
  v_mul_f32 v131, v131, v11
  v_mul_f32 v132, v132, v11
  v_mul_f32 v133, v133, v11
  v_mul_f32 v134, v134, v11
  v_mul_f32 v135, v135, v11
  v_cvt_pk_bf16_f32 v240, v128, v129
  v_cvt_pk_bf16_f32 v241, v130, v131
  v_cvt_pk_bf16_f32 v242, v132, v133
  v_cvt_pk_bf16_f32 v243, v134, v135
  ds_write_b128 v13, v[240:243] offset:8192
  v_mul_f32 v136, v136, v11
  v_mul_f32 v137, v137, v11
  v_mul_f32 v138, v138, v11
  v_mul_f32 v139, v139, v11
  v_mul_f32 v140, v140, v11
  v_mul_f32 v141, v141, v11
  v_mul_f32 v142, v142, v11
  v_mul_f32 v143, v143, v11
  v_cvt_pk_bf16_f32 v244, v136, v137
  v_cvt_pk_bf16_f32 v245, v138, v139
  v_cvt_pk_bf16_f32 v246, v140, v141
  v_cvt_pk_bf16_f32 v247, v142, v143
  ds_write_b128 v13, v[244:247] offset:10240
  v_mul_f32 v144, v144, v11
  v_mul_f32 v145, v145, v11
  v_mul_f32 v146, v146, v11
  v_mul_f32 v147, v147, v11
  v_mul_f32 v148, v148, v11
  v_mul_f32 v149, v149, v11
  v_mul_f32 v150, v150, v11
  v_mul_f32 v151, v151, v11
  v_cvt_pk_bf16_f32 v248, v144, v145
  v_cvt_pk_bf16_f32 v249, v146, v147
  v_cvt_pk_bf16_f32 v250, v148, v149
  v_cvt_pk_bf16_f32 v251, v150, v151
  ds_write_b128 v13, v[248:251] offset:12288
  v_mul_f32 v152, v152, v11
  v_mul_f32 v153, v153, v11
  v_mul_f32 v154, v154, v11
  v_mul_f32 v155, v155, v11
  v_mul_f32 v156, v156, v11
  v_mul_f32 v157, v157, v11
  v_mul_f32 v158, v158, v11
  v_mul_f32 v159, v159, v11
  v_cvt_pk_bf16_f32 v252, v152, v153
  v_cvt_pk_bf16_f32 v253, v154, v155
  v_cvt_pk_bf16_f32 v254, v156, v157
  v_cvt_pk_bf16_f32 v255, v158, v159
  ds_write_b128 v13, v[252:255] offset:14336
  s_waitcnt vmcnt(8)
  s_waitcnt lgkmcnt(0)
  s_barrier
  s_lshl_b32 s70, s78, 12
  s_add_u32 s70, s70, 98304
  v_add_u32 v13, s70, v2
  s_add_u32 s78, s78, 1
  s_and_b32 s78, s78, 15
  ds_read_b128 v[80:83], v13 offset:0
  ds_read_b128 v[84:87], v13 offset:1024
  ds_read_b64_tr_b16 v[48:49], v26 offset:0
  ds_read_b64_tr_b16 v[50:51], v26 offset:8192
  ds_read_b64_tr_b16 v[52:53], v27 offset:0
  ds_read_b64_tr_b16 v[54:55], v27 offset:8192
  ds_read_b128 v[88:91], v13 offset:2048
  ds_read_b128 v[92:95], v13 offset:3072
  ds_read_b64_tr_b16 v[56:57], v26 offset:16384
  ds_read_b64_tr_b16 v[58:59], v26 offset:24576
  ds_read_b64_tr_b16 v[60:61], v27 offset:16384
  ds_read_b64_tr_b16 v[62:63], v27 offset:24576
  s_waitcnt lgkmcnt(8)
  v_mfma_f32_32x32x16_bf16 v[96:111], v[48:51], v[80:83], 0
  v_mfma_f32_32x32x16_bf16 v[128:143], v[48:51], v[84:87], 0
  s_waitcnt lgkmcnt(6)
  v_mfma_f32_32x32x16_bf16 v[112:127], v[52:55], v[80:83], 0
  v_mfma_f32_32x32x16_bf16 v[144:159], v[52:55], v[84:87], 0
  s_mov_b32 s11, 5
  s_nop 10
L_op:
  s_waitcnt vmcnt(4)
  s_waitcnt lgkmcnt(0)
  s_barrier
  s_lshl_b32 s70, s78, 12
  s_add_u32 s70, s70, 98304
  v_add_u32 v13, s70, v2
  s_add_u32 s78, s78, 1
  s_and_b32 s78, s78, 15
  ds_read_b128 v[80:83], v13 offset:0
  ds_read_b128 v[84:87], v13 offset:1024
  ds_read_b64_tr_b16 v[48:49], v26 offset:32768
  ds_read_b64_tr_b16 v[50:51], v26 offset:40960
  ds_read_b64_tr_b16 v[52:53], v27 offset:32768
  ds_read_b64_tr_b16 v[54:55], v27 offset:40960
  v_mfma_f32_32x32x16_bf16 v[96:111], v[56:59], v[88:91], v[96:111]
  s_lshl_b32 s69, s10, 15
  s_add_u32 s69, s69, s77
  s_add_u32 m0, s75, 0
  s_add_u32 s10, s10, 1
  s_and_b32 s10, s10, 15
  buffer_load_dwordx4 v18, s[60:63], s69 offen offset:0 lds
  v_mfma_f32_32x32x16_bf16 v[128:143], v[56:59], v[92:95], v[128:143]
  v_mfma_f32_32x32x16_bf16 v[112:127], v[60:63], v[88:91], v[112:127]
  buffer_load_dwordx4 v19, s[60:63], s69 offen offset:1024 lds
  v_mfma_f32_32x32x16_bf16 v[144:159], v[60:63], v[92:95], v[144:159]
  ds_read_b128 v[88:91], v13 offset:2048
  ds_read_b128 v[92:95], v13 offset:3072
  ds_read_b64_tr_b16 v[56:57], v26 offset:49152
  ds_read_b64_tr_b16 v[58:59], v26 offset:57344
  ds_read_b64_tr_b16 v[60:61], v27 offset:49152
  ds_read_b64_tr_b16 v[62:63], v27 offset:57344
  s_waitcnt lgkmcnt(8)
  v_mfma_f32_32x32x16_bf16 v[96:111], v[48:51], v[80:83], v[96:111]
  buffer_load_dwordx4 v20, s[60:63], s69 offen offset:2048 lds
  v_mfma_f32_32x32x16_bf16 v[128:143], v[48:51], v[84:87], v[128:143]
  s_waitcnt lgkmcnt(6)
  v_mfma_f32_32x32x16_bf16 v[112:127], v[52:55], v[80:83], v[112:127]
  buffer_load_dwordx4 v21, s[60:63], s69 offen offset:3072 lds
  v_mfma_f32_32x32x16_bf16 v[144:159], v[52:55], v[84:87], v[144:159]
  s_waitcnt vmcnt(4)
  s_waitcnt lgkmcnt(0)
  s_barrier
  s_cmp_eq_u32 s11, 1
  s_cselect_b32 s62, 0, s62
  s_lshl_b32 s70, s78, 12
  s_add_u32 s70, s70, 98304
  v_add_u32 v13, s70, v2
  s_add_u32 s78, s78, 1
  s_and_b32 s78, s78, 15
  ds_read_b128 v[80:83], v13 offset:0
  ds_read_b128 v[84:87], v13 offset:1024
  ds_read_b64_tr_b16 v[48:49], v28 offset:0
  ds_read_b64_tr_b16 v[50:51], v28 offset:8192
  ds_read_b64_tr_b16 v[52:53], v29 offset:0
  ds_read_b64_tr_b16 v[54:55], v29 offset:8192
  v_mfma_f32_32x32x16_bf16 v[96:111], v[56:59], v[88:91], v[96:111]
  s_lshl_b32 s69, s10, 15
  s_add_u32 s69, s69, s77
  s_add_u32 m0, s75, 32768
  s_add_u32 s10, s10, 1
  s_and_b32 s10, s10, 15
  buffer_load_dwordx4 v18, s[60:63], s69 offen offset:0 lds
  v_mfma_f32_32x32x16_bf16 v[128:143], v[56:59], v[92:95], v[128:143]
  v_mfma_f32_32x32x16_bf16 v[112:127], v[60:63], v[88:91], v[112:127]
  buffer_load_dwordx4 v19, s[60:63], s69 offen offset:1024 lds
  v_mfma_f32_32x32x16_bf16 v[144:159], v[60:63], v[92:95], v[144:159]
  ds_read_b128 v[88:91], v13 offset:2048
  ds_read_b128 v[92:95], v13 offset:3072
  ds_read_b64_tr_b16 v[56:57], v28 offset:16384
  ds_read_b64_tr_b16 v[58:59], v28 offset:24576
  ds_read_b64_tr_b16 v[60:61], v29 offset:16384
  ds_read_b64_tr_b16 v[62:63], v29 offset:24576
  s_waitcnt lgkmcnt(8)
  v_mfma_f32_32x32x16_bf16 v[96:111], v[48:51], v[80:83], v[96:111]
  buffer_load_dwordx4 v20, s[60:63], s69 offen offset:2048 lds
  v_mfma_f32_32x32x16_bf16 v[128:143], v[48:51], v[84:87], v[128:143]
  s_waitcnt lgkmcnt(6)
  v_mfma_f32_32x32x16_bf16 v[112:127], v[52:55], v[80:83], v[112:127]
  buffer_load_dwordx4 v21, s[60:63], s69 offen offset:3072 lds
  v_mfma_f32_32x32x16_bf16 v[144:159], v[52:55], v[84:87], v[144:159]
  s_waitcnt vmcnt(4)
  s_waitcnt lgkmcnt(0)
  s_barrier
  s_lshl_b32 s70, s78, 12
  s_add_u32 s70, s70, 98304
  v_add_u32 v13, s70, v2
  s_add_u32 s78, s78, 1
  s_and_b32 s78, s78, 15
  ds_read_b128 v[80:83], v13 offset:0
  ds_read_b128 v[84:87], v13 offset:1024
  ds_read_b64_tr_b16 v[48:49], v26 offset:0
  ds_read_b64_tr_b16 v[50:51], v26 offset:8192
  ds_read_b64_tr_b16 v[52:53], v27 offset:0
  ds_read_b64_tr_b16 v[54:55], v27 offset:8192
  v_mfma_f32_32x32x16_bf16 v[96:111], v[56:59], v[88:91], v[96:111]
  s_lshl_b32 s69, s10, 15
  s_add_u32 s69, s69, s77
  s_add_u32 m0, s75, 65536
  s_add_u32 s10, s10, 1
  s_and_b32 s10, s10, 15
  buffer_load_dwordx4 v18, s[60:63], s69 offen offset:0 lds
  v_mfma_f32_32x32x16_bf16 v[128:143], v[56:59], v[92:95], v[128:143]
  v_mfma_f32_32x32x16_bf16 v[112:127], v[60:63], v[88:91], v[112:127]
  buffer_load_dwordx4 v19, s[60:63], s69 offen offset:1024 lds
  v_mfma_f32_32x32x16_bf16 v[144:159], v[60:63], v[92:95], v[144:159]
  ds_read_b128 v[88:91], v13 offset:2048
  ds_read_b128 v[92:95], v13 offset:3072
  ds_read_b64_tr_b16 v[56:57], v26 offset:16384
  ds_read_b64_tr_b16 v[58:59], v26 offset:24576
  ds_read_b64_tr_b16 v[60:61], v27 offset:16384
  ds_read_b64_tr_b16 v[62:63], v27 offset:24576
  s_waitcnt lgkmcnt(8)
  v_mfma_f32_32x32x16_bf16 v[96:111], v[48:51], v[80:83], v[96:111]
  buffer_load_dwordx4 v20, s[60:63], s69 offen offset:2048 lds
  v_mfma_f32_32x32x16_bf16 v[128:143], v[48:51], v[84:87], v[128:143]
  s_waitcnt lgkmcnt(6)
  v_mfma_f32_32x32x16_bf16 v[112:127], v[52:55], v[80:83], v[112:127]
  buffer_load_dwordx4 v21, s[60:63], s69 offen offset:3072 lds
  v_mfma_f32_32x32x16_bf16 v[144:159], v[52:55], v[84:87], v[144:159]
  s_sub_u32 s11, s11, 1
  s_cmp_lg_u32 s11, 0
  s_nop 9
  s_cbranch_scc1 L_op
  s_waitcnt lgkmcnt(2)
  v_mfma_f32_32x32x16_bf16 v[96:111], v[56:59], v[88:91], v[96:111]
  v_mfma_f32_32x32x16_bf16 v[128:143], v[56:59], v[92:95], v[128:143]
  s_waitcnt lgkmcnt(0)
  v_mfma_f32_32x32x16_bf16 v[112:127], v[60:63], v[88:91], v[112:127]
  v_mfma_f32_32x32x16_bf16 v[144:159], v[60:63], v[92:95], v[144:159]
  s_lshl_b32 s70, s5, 16
  s_lshl_b32 s69, s3, 13
  s_add_u32 s70, s70, s69
  s_add_u32 s69, s70, 0
  s_nop 3
  v_cvt_pk_bf16_f32 v224, v96, v97
  v_cvt_pk_bf16_f32 v225, v98, v99
  v_cvt_pk_bf16_f32 v226, v100, v101
  v_cvt_pk_bf16_f32 v227, v102, v103
  buffer_store_dwordx4 v[224:227], v2, s[64:67], s69 offen offset:0 sc1
  v_cvt_pk_bf16_f32 v228, v104, v105
  v_cvt_pk_bf16_f32 v229, v106, v107
  v_cvt_pk_bf16_f32 v230, v108, v109
  v_cvt_pk_bf16_f32 v231, v110, v111
  buffer_store_dwordx4 v[228:231], v2, s[64:67], s69 offen offset:1024 sc1
  v_cvt_pk_bf16_f32 v232, v112, v113
  v_cvt_pk_bf16_f32 v233, v114, v115
  v_cvt_pk_bf16_f32 v234, v116, v117
  v_cvt_pk_bf16_f32 v235, v118, v119
  buffer_store_dwordx4 v[232:235], v2, s[64:67], s69 offen offset:2048 sc1
  v_cvt_pk_bf16_f32 v236, v120, v121
  v_cvt_pk_bf16_f32 v237, v122, v123
  v_cvt_pk_bf16_f32 v238, v124, v125
  v_cvt_pk_bf16_f32 v239, v126, v127
  buffer_store_dwordx4 v[236:239], v2, s[64:67], s69 offen offset:3072 sc1
  s_add_u32 s69, s70, 4096
  v_cvt_pk_bf16_f32 v240, v128, v129
  v_cvt_pk_bf16_f32 v241, v130, v131
  v_cvt_pk_bf16_f32 v242, v132, v133
  v_cvt_pk_bf16_f32 v243, v134, v135
  buffer_store_dwordx4 v[240:243], v2, s[64:67], s69 offen offset:0 sc1
  v_cvt_pk_bf16_f32 v244, v136, v137
  v_cvt_pk_bf16_f32 v245, v138, v139
  v_cvt_pk_bf16_f32 v246, v140, v141
  v_cvt_pk_bf16_f32 v247, v142, v143
  buffer_store_dwordx4 v[244:247], v2, s[64:67], s69 offen offset:1024 sc1
  v_cvt_pk_bf16_f32 v248, v144, v145
  v_cvt_pk_bf16_f32 v249, v146, v147
  v_cvt_pk_bf16_f32 v250, v148, v149
  v_cvt_pk_bf16_f32 v251, v150, v151
  buffer_store_dwordx4 v[248:251], v2, s[64:67], s69 offen offset:2048 sc1
  v_cvt_pk_bf16_f32 v252, v152, v153
  v_cvt_pk_bf16_f32 v253, v154, v155
  v_cvt_pk_bf16_f32 v254, v156, v157
  v_cvt_pk_bf16_f32 v255, v158, v159
  buffer_store_dwordx4 v[252:255], v2, s[64:67], s69 offen offset:3072 sc1
  s_lshl_b32 s69, s4, 17
  s_add_u32 s44, s36, s69
  s_addc_u32 s45, s37, 0
  s_and_b32 s45, s45, 0xffff
  s_mov_b32 s46, 131072
  s_mov_b32 s47, 0x20000
  v_lshlrev_b32 v4, 11, v4
  v_lshl_add_u32 v3, v3, 4, v4
  v_mov_b32 v5, 0
  v_lshlrev_b32 v13, 2, v1
  s_lshl_b32 s12, s5, 2
  s_waitcnt vmcnt(0)
  v_readfirstlane_b32 s69, v16
  s_nop 0
  s_cmp_eq_u32 s69, 0
  s_cselect_b32 s42, s42, s69
  v_mov_b32 v9, s42
  s_barrier
  s_cmp_lg_u32 s3, 0
  s_cbranch_scc1 L_wait
  s_mov_b64 exec, 1
  buffer_store_dword v9, v5, s[96:99], s12 offen sc1
  s_mov_b64 exec, 0xffff
  s_lshl_b32 s74, 1, s5
  s_mov_b32 s15, 4000
L_poll:
  buffer_load_dword v6, v13, s[96:99], 0 offen sc1
  s_waitcnt vmcnt(0)
  v_cmp_eq_u32 vcc, v6, v9
  s_nop 4
  s_and_b32 s69, vcc_lo, 0xff
  s_cmp_eq_u32 s69, 0xff
  s_cbranch_scc1 L_arrived
  s_cmp_eq_u32 s15, 0
  s_cbranch_scc1 L_giveup
  s_sub_u32 s15, s15, 1
  s_cmp_lg_u32 s15, 0
  s_cbranch_scc1 L_poll
  s_mov_b64 exec, 1
  buffer_store_dword v9, v5, s[96:99], s12 offen offset:32 sc1
  s_waitcnt vmcnt(0)
  s_mov_b64 exec, 0xffff
  s_branch L_poll
L_giveup:
  s_mov_b32 s74, 0
  s_branch L_pub0
L_arrived:
  s_lshr_b32 s69, vcc_lo, 8
  s_and_b32 s69, s69, 0xff
  s_or_b32 s74, s74, s69
L_pub0:
  s_mov_b64 exec, 1
  v_mov_b32 v6, s74
  ds_write_b32 v5, v6
  s_mov_b64 exec, -1
  s_waitcnt lgkmcnt(0)
L_wait:
  s_barrier
  ds_read_b32 v6, v5
  s_waitcnt lgkmcnt(0)
  v_readfirstlane_b32 s74, v6
L_share:
  s_nop 0
  s_cmp_eq_u32 s74, 0
  s_cbranch_scc1 L_fin
  s_ff1_i32_b32 s69, s74
  s_lshl_b32 s70, 1, s69
  s_xor_b32 s74, s74, s70
  s_lshl_b32 s10, s69, 13
  s_add_u32 s10, s10, s76
  s_lshl_b32 s78, s69, 7
  s_lshr_b32 s70, s3, 2
  s_lshl_b32 s70, s70, 16
  s_add_u32 s78, s78, s70
  s_and_b32 s70, s3, 3
  s_lshl_b32 s70, s70, 5
  s_add_u32 s78, s78, s70
  s_xor_b32 s70, s7, 1
  s_lshl_b32 s70, s70, 10
  s_add_u32 s78, s78, s70
  s_add_u32 s71, s10, 0
  buffer_load_dwordx4 v[96:99], v2, s[64:67], s71 offen sc1
  s_add_u32 s71, s10, 65536
  buffer_load_dwordx4 v[100:103], v2, s[64:67], s71 offen sc1
  s_add_u32 s71, s10, 131072
  buffer_load_dwordx4 v[104:107], v2, s[64:67], s71 offen sc1
  s_add_u32 s71, s10, 196608
  buffer_load_dwordx4 v[108:111], v2, s[64:67], s71 offen sc1
  s_add_u32 s71, s10, 262144
  buffer_load_dwordx4 v[112:115], v2, s[64:67], s71 offen sc1
  s_add_u32 s71, s10, 327680
  buffer_load_dwordx4 v[116:119], v2, s[64:67], s71 offen sc1
  s_add_u32 s71, s10, 393216
  buffer_load_dwordx4 v[120:123], v2, s[64:67], s71 offen sc1
  s_add_u32 s71, s10, 458752
  buffer_load_dwordx4 v[124:127], v2, s[64:67], s71 offen sc1
  s_mov_b32 s72, 0xffff0000
  s_waitcnt vmcnt(7)
  v_lshlrev_b32 v64, 16, v96
  v_and_b32 v65, s72, v96
  v_lshlrev_b32 v66, 16, v97
  v_and_b32 v67, s72, v97
  v_lshlrev_b32 v68, 16, v98
  v_and_b32 v69, s72, v98
  v_lshlrev_b32 v70, 16, v99
  v_and_b32 v71, s72, v99
  s_waitcnt vmcnt(6)
  v_lshlrev_b32 v80, 16, v100
  v_and_b32 v81, s72, v100
  v_add_f32 v64, v64, v80
  v_add_f32 v65, v65, v81
  v_lshlrev_b32 v82, 16, v101
  v_and_b32 v83, s72, v101
  v_add_f32 v66, v66, v82
  v_add_f32 v67, v67, v83
  v_lshlrev_b32 v84, 16, v102
  v_and_b32 v85, s72, v102
  v_add_f32 v68, v68, v84
  v_add_f32 v69, v69, v85
  v_lshlrev_b32 v86, 16, v103
  v_and_b32 v87, s72, v103
  v_add_f32 v70, v70, v86
  v_add_f32 v71, v71, v87
  s_waitcnt vmcnt(5)
  v_lshlrev_b32 v80, 16, v104
  v_and_b32 v81, s72, v104
  v_add_f32 v64, v64, v80
  v_add_f32 v65, v65, v81
  v_lshlrev_b32 v82, 16, v105
  v_and_b32 v83, s72, v105
  v_add_f32 v66, v66, v82
  v_add_f32 v67, v67, v83
  v_lshlrev_b32 v84, 16, v106
  v_and_b32 v85, s72, v106
  v_add_f32 v68, v68, v84
  v_add_f32 v69, v69, v85
  v_lshlrev_b32 v86, 16, v107
  v_and_b32 v87, s72, v107
  v_add_f32 v70, v70, v86
  v_add_f32 v71, v71, v87
  s_waitcnt vmcnt(4)
  v_lshlrev_b32 v80, 16, v108
  v_and_b32 v81, s72, v108
  v_add_f32 v64, v64, v80
  v_add_f32 v65, v65, v81
  v_lshlrev_b32 v82, 16, v109
  v_and_b32 v83, s72, v109
  v_add_f32 v66, v66, v82
  v_add_f32 v67, v67, v83
  v_lshlrev_b32 v84, 16, v110
  v_and_b32 v85, s72, v110
  v_add_f32 v68, v68, v84
  v_add_f32 v69, v69, v85
  v_lshlrev_b32 v86, 16, v111
  v_and_b32 v87, s72, v111
  v_add_f32 v70, v70, v86
  v_add_f32 v71, v71, v87
  s_waitcnt vmcnt(3)
  v_lshlrev_b32 v80, 16, v112
  v_and_b32 v81, s72, v112
  v_add_f32 v64, v64, v80
  v_add_f32 v65, v65, v81
  v_lshlrev_b32 v82, 16, v113
  v_and_b32 v83, s72, v113
  v_add_f32 v66, v66, v82
  v_add_f32 v67, v67, v83
  v_lshlrev_b32 v84, 16, v114
  v_and_b32 v85, s72, v114
  v_add_f32 v68, v68, v84
  v_add_f32 v69, v69, v85
  v_lshlrev_b32 v86, 16, v115
  v_and_b32 v87, s72, v115
  v_add_f32 v70, v70, v86
  v_add_f32 v71, v71, v87
  s_waitcnt vmcnt(2)
  v_lshlrev_b32 v80, 16, v116
  v_and_b32 v81, s72, v116
  v_add_f32 v64, v64, v80
  v_add_f32 v65, v65, v81
  v_lshlrev_b32 v82, 16, v117
  v_and_b32 v83, s72, v117
  v_add_f32 v66, v66, v82
  v_add_f32 v67, v67, v83
  v_lshlrev_b32 v84, 16, v118
  v_and_b32 v85, s72, v118
  v_add_f32 v68, v68, v84
  v_add_f32 v69, v69, v85
  v_lshlrev_b32 v86, 16, v119
  v_and_b32 v87, s72, v119
  v_add_f32 v70, v70, v86
  v_add_f32 v71, v71, v87
  s_waitcnt vmcnt(1)
  v_lshlrev_b32 v80, 16, v120
  v_and_b32 v81, s72, v120
  v_add_f32 v64, v64, v80
  v_add_f32 v65, v65, v81
  v_lshlrev_b32 v82, 16, v121
  v_and_b32 v83, s72, v121
  v_add_f32 v66, v66, v82
  v_add_f32 v67, v67, v83
  v_lshlrev_b32 v84, 16, v122
  v_and_b32 v85, s72, v122
  v_add_f32 v68, v68, v84
  v_add_f32 v69, v69, v85
  v_lshlrev_b32 v86, 16, v123
  v_and_b32 v87, s72, v123
  v_add_f32 v70, v70, v86
  v_add_f32 v71, v71, v87
  s_waitcnt vmcnt(0)
  v_lshlrev_b32 v80, 16, v124
  v_and_b32 v81, s72, v124
  v_add_f32 v64, v64, v80
  v_add_f32 v65, v65, v81
  v_lshlrev_b32 v82, 16, v125
  v_and_b32 v83, s72, v125
  v_add_f32 v66, v66, v82
  v_add_f32 v67, v67, v83
  v_lshlrev_b32 v84, 16, v126
  v_and_b32 v85, s72, v126
  v_add_f32 v68, v68, v84
  v_add_f32 v69, v69, v85
  v_lshlrev_b32 v86, 16, v127
  v_and_b32 v87, s72, v127
  v_add_f32 v70, v70, v86
  v_add_f32 v71, v71, v87
  v_cvt_pk_bf16_f32 v88, v64, v65
  v_cvt_pk_bf16_f32 v89, v66, v67
  v_cvt_pk_bf16_f32 v90, v68, v69
  v_cvt_pk_bf16_f32 v91, v70, v71
  buffer_store_dwordx4 v[88:91], v3, s[44:47], s78 offen
  s_nop 1
  s_branch L_share
L_fin:
L_end:
  s_endpgm
L_slow:
  v_sub_f32 v10, 0, v9
  v_min_f32 v10, v10, v7
  v_sub_f32 v11, v10, v7
  v_exp_f32 v11, v11
  v_mov_b32 v7, v10
  v_mul_f32 v8, v8, v11
  v_mul_f32 v96, v96, v11
  v_mul_f32 v97, v97, v11
  v_mul_f32 v98, v98, v11
  v_mul_f32 v99, v99, v11
  v_mul_f32 v100, v100, v11
  v_mul_f32 v101, v101, v11
  v_mul_f32 v102, v102, v11
  v_mul_f32 v103, v103, v11
  v_mul_f32 v104, v104, v11
  v_mul_f32 v105, v105, v11
  v_mul_f32 v106, v106, v11
  v_mul_f32 v107, v107, v11
  v_mul_f32 v108, v108, v11
  v_mul_f32 v109, v109, v11
  v_mul_f32 v110, v110, v11
  v_mul_f32 v111, v111, v11
  v_mul_f32 v112, v112, v11
  v_mul_f32 v113, v113, v11
  v_mul_f32 v114, v114, v11
  v_mul_f32 v115, v115, v11
  v_mul_f32 v116, v116, v11
  v_mul_f32 v117, v117, v11
  v_mul_f32 v118, v118, v11
  v_mul_f32 v119, v119, v11
  v_mul_f32 v120, v120, v11
  v_mul_f32 v121, v121, v11
  v_mul_f32 v122, v122, v11
  v_mul_f32 v123, v123, v11
  v_mul_f32 v124, v124, v11
  v_mul_f32 v125, v125, v11
  v_mul_f32 v126, v126, v11
  v_mul_f32 v127, v127, v11
  v_mul_f32 v128, v128, v11
  v_mul_f32 v129, v129, v11
  v_mul_f32 v130, v130, v11
  v_mul_f32 v131, v131, v11
  v_mul_f32 v132, v132, v11
  v_mul_f32 v133, v133, v11
  v_mul_f32 v134, v134, v11
  v_mul_f32 v135, v135, v11
  v_mul_f32 v136, v136, v11
  v_mul_f32 v137, v137, v11
  v_mul_f32 v138, v138, v11
  v_mul_f32 v139, v139, v11
  v_mul_f32 v140, v140, v11
  v_mul_f32 v141, v141, v11
  v_mul_f32 v142, v142, v11
  v_mul_f32 v143, v143, v11
  v_mul_f32 v144, v144, v11
  v_mul_f32 v145, v145, v11
  v_mul_f32 v146, v146, v11
  v_mul_f32 v147, v147, v11
  v_mul_f32 v148, v148, v11
  v_mul_f32 v149, v149, v11
  v_mul_f32 v150, v150, v11
  v_mul_f32 v151, v151, v11
  v_mul_f32 v152, v152, v11
  v_mul_f32 v153, v153, v11
  v_mul_f32 v154, v154, v11
  v_mul_f32 v155, v155, v11
  v_mul_f32 v156, v156, v11
  v_mul_f32 v157, v157, v11
  v_mul_f32 v158, v158, v11
  v_mul_f32 v159, v159, v11
  s_nop 1
  s_setpc_b64 s[80:81]
.section .rodata,"a"
.p2align 6
.amdhsa_kernel concat_heads__gqa_block_cached__mha_block_cached__near_ridge_kernel
  .amdhsa_next_free_vgpr 256
  .amdhsa_next_free_sgpr 102
  .amdhsa_accum_offset 256
  .amdhsa_group_segment_fixed_size 0
  .amdhsa_kernarg_size 104
  .amdhsa_user_sgpr_count 2
  .amdhsa_user_sgpr_kernarg_segment_ptr 1
  .amdhsa_system_sgpr_workgroup_id_x 1
.end_amdhsa_kernel
```
